```python
import torch

def _softmax(x, axis=-1):
    return torch.softmax(x, dim=axis)
def _gelu(x):
    return torch.nn.functional.gelu(x, approximate="tanh")
def _silu(x):
    return torch.nn.functional.silu(x)
def _sigmoid(x):
    return torch.sigmoid(x)
def _layernorm(x, axis=-1, eps=1e-5):
    m = x.mean(dim=axis, keepdim=True)
    v = x.var(dim=axis, keepdim=True, unbiased=False)
    return (x - m) / torch.sqrt(v + eps)
def _scatter_add(tgt, idx, src, axis=0):
    return tgt.clone().index_add_(axis, idx, src)
def _segment_sum(src, seg, n):
    out = torch.zeros((n,) + src.shape[1:], dtype=src.dtype)
    return out.index_add_(0, seg, src)
def _pad(x, pw):
    flat = tuple(v for pair in reversed(pw) for v in pair)
    return torch.nn.functional.pad(x, flat)

kernel_name = 'gated_mix__softmax_full_mha__ssm_conv_s4d__prompt'

def setup_inputs():

    _w = (lambda a: (lambda t: t.to(torch.bfloat16) if t.is_floating_point() else t)(torch.as_tensor(a)))
    def _A_setup():
        B, S, D = 1, 2048, 512
        return {
            "x": _w((lambda *s: torch.randn(*s, dtype=torch.bfloat16) * 0.05)(B, S, D)),
            "wqkv": _w((lambda *s: torch.randn(*s, dtype=torch.bfloat16) * 0.8)(D, 3 * D)),
            "wo": _w((lambda *s: torch.randn(*s, dtype=torch.bfloat16) * 0.05)(D, D)),
        }
    _A_in = _A_setup()

    def _B_setup():
        Bsz, L, D, N = 1, 2048, 512, 128
        return {
            "u": _w((lambda *s: torch.randn(*s, dtype=torch.bfloat16) * 0.05)(Bsz, L, D)),
            "log_A_real": _w((lambda *s: torch.randn(*s, dtype=torch.bfloat16) * 6.4)(D, N) * 0.5),
            "A_imag": _w((lambda *s: torch.randn(*s, dtype=torch.bfloat16) * 0.1)(D, N) * 3.14),
            "C_real": _w((lambda *s: torch.randn(*s, dtype=torch.bfloat16) * 0.4)(D, N) / N ** 0.5),
            "C_imag": _w((lambda *s: torch.randn(*s, dtype=torch.bfloat16) * 0.4)(D, N) / N ** 0.5),
            "log_dt": _w((lambda *s: torch.randn(*s, dtype=torch.bfloat16) * 0.1)(D) * 0.5 - 4.0),
            "D_skip": _w((lambda *s: torch.randn(*s, dtype=torch.bfloat16) * 0.1)(D)),
        }
    _B_in = _B_setup()

    return {
        "A_x": _A_in["x"],
        "A_wqkv": _A_in["wqkv"],
        "A_wo": _A_in["wo"],
        "B_u": _B_in["u"],
        "B_log_A_real": _B_in["log_A_real"],
        "B_A_imag": _B_in["A_imag"],
        "B_C_real": _B_in["C_real"],
        "B_C_imag": _B_in["C_imag"],
        "B_log_dt": _B_in["log_dt"],
        "B_D_skip": _B_in["D_skip"],
        "gate_w": _w((lambda *s: torch.randn(*s, dtype=torch.bfloat16) * 0.05)(512) * 16.0),
    }

def reference(A_x, A_wqkv, A_wo, B_u, B_log_A_real, B_A_imag, B_C_real, B_C_imag, B_log_dt, B_D_skip, gate_w):
    def _A_ref(x, wqkv, wo):
        B, S, D = x.shape
        H = 32; Dh = D // H
        qkv = (lambda x, *d: x.permute(*d))((x @ wqkv).reshape(B, S, 3, H, Dh), 2, 0, 3, 1, 4)
        q, k, v = qkv[0], qkv[1], qkv[2]
        scale = Dh ** -0.5
        scores = torch.einsum("bhqd,bhkd->bhqk", q, k) * scale
        p = _softmax(scores, axis=-1)
        o = torch.einsum("bhqk,bhkd->bhqd", p, v)
        return (lambda x, *d: x.permute(*d))(o, 0, 2, 1, 3).reshape(B, S, D) @ wo

    def _B_ref(u, log_A_real, A_imag, C_real, C_imag, log_dt, D_skip):
        L = u.shape[1]
        dt = torch.exp(log_dt)
        A = -torch.exp(log_A_real) + 1j * A_imag
        C = (C_real + 1j * C_imag) * dt[:, None]
        pos = (lambda x, dt: x.to(dt))(torch.arange(L), log_dt.dtype)
        P = torch.exp((A * dt[:, None])[:, :, None] * pos[None, None, :])
        K = 2.0 * torch.einsum("dn,dnl->dl", C, P).real
        L2 = 2 * L
        u_t = (lambda x, *d: x.permute(*d))(u, 0, 2, 1)
        Kf = (lambda x, *a, **k: torch.fft.rfft(x.float(), *a, **k))(K, L2)
        Uf = (lambda x, *a, **k: torch.fft.rfft(x.float(), *a, **k))(u_t, L2)
        y = (lambda x, *a, **k: torch.fft.irfft(x, *a, **k).to(torch.bfloat16))(Uf * Kf[None, :, :], L2)[:, :, :L]
        y = (lambda x, *d: x.permute(*d))(y, 0, 2, 1)
        return y + u * D_skip[None, None, :]

    x = A_x
    g = _sigmoid((x * gate_w).sum(-1, keepdims=True))
    a = _A_ref(x, A_wqkv, A_wo)
    b = _B_ref(x, B_log_A_real, B_A_imag, B_C_real, B_C_imag, B_log_dt, B_D_skip)
    return g * a + (1 - g) * b
```

```asm
; @launch grid=(256,1,1) block=(768,1,1) lds=163840
.amdgcn_target "amdgcn-amd-amdhsa--gfx950"
.text
.globl gated_mix__softmax_full_mha__ssm_conv_s4d__prompt_kernel
.p2align 8
.type gated_mix__softmax_full_mha__ssm_conv_s4d__prompt_kernel,@function
gated_mix__softmax_full_mha__ssm_conv_s4d__prompt_kernel:
    s_cmp_ge_u32 s2, 256
    s_cbranch_scc1 L_END
    s_load_dwordx4 s[4:7], s[0:1], 0
    s_load_dwordx2 s[8:9], s[0:1], 16
    s_load_dwordx8 s[12:19], s[0:1], 32
    s_load_dwordx4 s[20:23], s[0:1], 64
    s_load_dwordx2 s[24:25], s[0:1], 80
    s_load_dwordx4 s[28:31], s[0:1], 88
    s_load_dwordx2 s[26:27], s[0:1], 104
    v_lshrrev_b32 v1, 6, v0
    v_and_b32 v0, 63, v0
    v_readfirstlane_b32 s3, v1
    v_lshlrev_b32 v1, 4, v0
    v_mov_b32 v8, 0
    v_mov_b32 v9, 0
    v_mov_b32 v10, 0
    v_mov_b32 v11, 0
    v_add_u32 v5, 163328, v1
    s_mov_b64 exec, 0x3ff
    ds_write_b128 v5, v[8:11]
    s_mov_b64 exec, -1
    s_and_b32 s51, s2, 7
    s_lshr_b32 s52, s2, 3
    s_lshr_b32 s48, s51, 1
    s_lshl_b32 s48, s48, 2
    s_lshr_b32 s53, s52, 3
    s_add_u32 s48, s48, s53
    s_and_b32 s49, s51, 1
    s_lshl_b32 s49, s49, 3
    s_and_b32 s53, s52, 7
    s_add_u32 s49, s49, s53
    s_add_u32 s10, s48, s49
    s_and_b32 s10, s10, 1
    s_lshl_b32 s10, s10, 1
    s_lshr_b32 s53, s49, 3
    s_add_u32 s10, s10, s53
    s_lshl_b32 s10, s10, 1
    s_bfe_u32 s53, s48, 0x10002
    s_add_u32 s10, s10, s53
    s_bfe_u32 s97, s49, 0x20001
    s_xor_b32 s97, s97, 0
    v_and_b32 v2, 31, v0
    v_lshrrev_b32 v3, 5, v0
    v_lshrrev_b32 v5, 1, v2
    v_xor_b32 v5, v5, v2
    v_and_b32 v5, 4, v5
    v_mul_u32_u24 v5, 3, v5
    v_xor_b32 v4, v5, v2
    s_lshr_b32 s51, s3, 2
    s_cmp_eq_u32 s51, 1
    s_cbranch_scc1 L_KGEN
    s_waitcnt lgkmcnt(0)
    s_mov_b32 s32, s4
    s_and_b32 s33, s5, 0xffff
    s_mov_b32 s34, 0x200000
    s_mov_b32 s35, 0x20000
    s_mov_b32 s40, s26
    s_and_b32 s41, s27, 0xffff
    s_mov_b32 s42, 0xe00000
    s_mov_b32 s43, 0x20000
    s_barrier
    s_cmp_ge_u32 s3, 8
    s_cbranch_scc1 L_AUX
    s_cmp_ge_u32 s3, 4
    s_cbranch_scc1 L_KGEN
    s_lshl_b32 s51, s48, 2
    s_add_u32 s51, s51, s3
    s_lshl_b32 s52, s3, 12
    s_add_u32 s52, s52, 44544
    v_bfe_u32 v6, v4, 1, 3
    v_xor_b32 v6, v6, v3
    v_lshlrev_b32 v6, 4, v6
    v_lshl_add_u32 v6, v4, 7, v6
    v_add_u32 v8, s52, v6
    v_xor_b32 v7, 32, v6
    v_add_u32 v9, s52, v7
    v_xor_b32 v7, 64, v6
    v_add_u32 v10, s52, v7
    v_xor_b32 v7, 96, v6
    v_add_u32 v11, s52, v7
    v_bfe_u32 v6, v0, 2, 2
    v_lshl_add_u32 v6, v3, 3, v6
    v_lshlrev_b32 v6, 6, v6
    v_bfe_u32 v7, v0, 4, 1
    v_lshl_add_u32 v6, v7, 5, v6
    v_add_u32 v6, 32256, v6
    v_and_b32 v7, 3, v0
    v_lshl_add_u32 v13, v7, 3, v6
    v_bfrev_b32 v7, v7
    v_lshrrev_b32 v7, 30, v7
    v_lshl_add_u32 v12, v7, 3, v6
    v_mov_b32 v20, 163328
    s_lshl_b32 s52, s3, 2
    s_add_u32 s52, s52, 163344
    v_mov_b32 v21, s52
    v_add_u32 v14, 57344, v8
    v_add_u32 v15, 57344, v9
    v_add_u32 v16, 57344, v10
    v_add_u32 v17, 57344, v11
    v_add_u32 v18, 57344, v12
    v_add_u32 v19, 57344, v13
    s_lshl_b32 s56, s48, 7
    s_mul_i32 s57, s49, 4352
    s_add_u32 s56, s56, s57
    s_add_u32 s56, s56, 13766656
    s_lshl_b32 s57, s3, 11
    s_add_u32 s57, s57, 146944
    v_add_u32 v29, s57, v1
    s_and_b32 s52, s97, 1
    s_lshl_b32 s52, s52, 1
    s_and_b32 s53, s3, 1
    s_add_u32 s52, s52, s53
    s_lshl_b32 s52, s52, 1
    v_bfe_u32 v6, v0, 1, 1
    v_add_u32 v6, s52, v6
    v_bfe_u32 v7, v0, 3, 1
    v_xor_b32 v6, v6, v7
    v_lshlrev_b32 v6, 4, v6
    v_and_b32 v7, 1, v0
    v_lshl_add_u32 v6, v7, 3, v6
    v_bfe_u32 v7, v0, 2, 2
    v_lshl_add_u32 v6, v7, 7, v6
    v_lshrrev_b32 v7, 4, v0
    v_lshl_add_u32 v6, v7, 12, v6
    s_lshr_b32 s52, s97, 1
    s_mul_i32 s52, s52, 28672
    s_lshr_b32 s54, s3, 1
    s_lshl_b32 s55, s54, 11
    s_add_u32 s52, s52, s55
    s_add_u32 s52, s52, 44544
    v_add_u32 v144, s52, v6
    v_xor_b32 v145, 32, v144
    v_xor_b32 v146, 64, v144
    v_xor_b32 v147, 96, v144
    v_and_b32 v6, 15, v0
    v_lshl_add_u32 v6, v6, 2, v7
    s_lshl_b32 s53, s53, 12
    s_add_u32 s53, s53, s55
    s_add_u32 s53, s53, 146944
    v_lshl_add_u32 v29, v6, 4, s53
    v_mov_b32 v32, 0
    v_mov_b32 v33, 0
    v_mov_b32 v34, 0
    v_mov_b32 v35, 0
    v_mov_b32 v36, 0
    v_mov_b32 v37, 0
    v_mov_b32 v38, 0
    v_mov_b32 v39, 0
    v_mov_b32 v40, 0
    v_mov_b32 v41, 0
    v_mov_b32 v42, 0
    v_mov_b32 v43, 0
    v_mov_b32 v44, 0
    v_mov_b32 v45, 0
    v_mov_b32 v46, 0
    v_mov_b32 v47, 0
    v_mov_b32 v48, 0
    v_mov_b32 v49, 0
    v_mov_b32 v50, 0
    v_mov_b32 v51, 0
    v_mov_b32 v52, 0
    v_mov_b32 v53, 0
    v_mov_b32 v54, 0
    v_mov_b32 v55, 0
    v_mov_b32 v56, 0
    v_mov_b32 v57, 0
    v_mov_b32 v58, 0
    v_mov_b32 v59, 0
    v_mov_b32 v60, 0
    v_mov_b32 v61, 0
    v_mov_b32 v62, 0
    v_mov_b32 v63, 0
    v_mov_b32 v64, 0
    v_mov_b32 v65, 0
    v_mov_b32 v66, 0
    v_mov_b32 v67, 0
    v_mov_b32 v68, 0
    v_mov_b32 v69, 0
    v_mov_b32 v70, 0
    v_mov_b32 v71, 0
    v_mov_b32 v72, 0
    v_mov_b32 v73, 0
    v_mov_b32 v74, 0
    v_mov_b32 v75, 0
    v_mov_b32 v76, 0
    v_mov_b32 v77, 0
    v_mov_b32 v78, 0
    v_mov_b32 v79, 0
    s_setprio 1
    s_mov_b32 s65, 1048576
MW_1:
    ds_read_b128 v[24:27], v20
    s_waitcnt lgkmcnt(0)
MWC_3:
    v_min3_u32 v24, v24, v25, v26
    v_min_u32 v24, v24, v27
    s_sub_u32 s65, s65, 1
    s_cbranch_scc1 MWD_2
    v_readfirstlane_b32 s64, v24
    s_nop 0
    s_cmp_ge_u32 s64, 1
    s_cbranch_scc1 MWD_2
    s_sleep 1
    s_branch MW_1
MWD_2:
    s_mov_b32 s57, 0
    s_mov_b32 s63, 8
    s_mov_b32 s62, 0
    s_mov_b32 s61, 28672
    v_mov_b32 v28, 0
    s_mov_b32 s59, s97
    s_lshr_b32 s59, s97, 1
    s_cmp_lg_u32 s59, 0
    s_cbranch_scc1 L_XT_LATER
    ds_read_b64_tr_b16 v[160:161], v144 offset:0
    ds_read_b64_tr_b16 v[162:163], v145 offset:512
    ds_read_b64_tr_b16 v[164:165], v146 offset:1024
    ds_read_b64_tr_b16 v[166:167], v147 offset:1536
    s_waitcnt lgkmcnt(0)
    ds_write_b128 v29, v[160:163]
    ds_write_b128 v29, v[164:167] offset:1024
    ds_write_b32 v21, v21 offset:80
L_XT_LATER:
    ds_read_b128 v[80:83], v8 offset:0
    ds_read_b64_tr_b16 v[88:89], v12 offset:1024
    ds_read_b64_tr_b16 v[90:91], v12 offset:1280
    ds_read_b64_tr_b16 v[92:93], v13 offset:2048
    ds_read_b64_tr_b16 v[94:95], v13 offset:2304
    ds_read_b64_tr_b16 v[84:85], v12 offset:0
    ds_read_b64_tr_b16 v[86:87], v12 offset:256
    ds_read_b128 v[96:99], v9 offset:0
    ds_read_b64_tr_b16 v[104:105], v12 offset:4096
    ds_read_b64_tr_b16 v[106:107], v12 offset:4352
    ds_read_b64_tr_b16 v[108:109], v13 offset:5120
    ds_read_b64_tr_b16 v[110:111], v13 offset:5376
    ds_read_b64_tr_b16 v[100:101], v12 offset:3072
    ds_read_b64_tr_b16 v[102:103], v12 offset:3328
    ds_write_b32 v21, v28
L_GS:
    s_waitcnt lgkmcnt(8)
    v_mfma_f32_32x32x16_bf16 v[48:63], v[88:91], v[80:83], v[48:63]
    ds_read_b128 v[24:27], v20
    ds_read_b128 v[112:115], v10 offset:0
    ds_read_b64_tr_b16 v[120:121], v12 offset:7168
    ds_read_b64_tr_b16 v[122:123], v12 offset:7424
    v_mfma_f32_32x32x16_bf16 v[64:79], v[80:83], v[92:95], v[64:79]
    ds_read_b64_tr_b16 v[124:125], v13 offset:8192
    ds_read_b64_tr_b16 v[126:127], v13 offset:8448
    v_mfma_f32_32x32x16_bf16 v[32:47], v[84:87], v[80:83], v[32:47]
    ds_read_b64_tr_b16 v[116:117], v12 offset:6144
    ds_read_b64_tr_b16 v[118:119], v12 offset:6400
    s_add_u32 s58, s57, 2
    s_min_u32 s58, s58, s63
    s_waitcnt lgkmcnt(7)
    v_mfma_f32_32x32x16_bf16 v[48:63], v[104:107], v[96:99], v[48:63]
    ds_read_b128 v[128:131], v11 offset:0
    ds_read_b64_tr_b16 v[136:137], v12 offset:10240
    ds_read_b64_tr_b16 v[138:139], v12 offset:10496
    v_min3_u32 v24, v24, v25, v26
    v_min_u32 v24, v24, v27
    v_mfma_f32_32x32x16_bf16 v[64:79], v[96:99], v[108:111], v[64:79]
    ds_read_b64_tr_b16 v[140:141], v13 offset:11264
    ds_read_b64_tr_b16 v[142:143], v13 offset:11520
    v_readfirstlane_b32 s64, v24
    v_add_u32 v6, 1, v28
    v_mfma_f32_32x32x16_bf16 v[32:47], v[100:103], v[96:99], v[32:47]
    ds_read_b64_tr_b16 v[132:133], v12 offset:9216
    ds_read_b64_tr_b16 v[134:135], v12 offset:9472
    s_cmp_lt_u32 s64, s58
    s_cbranch_scc1 GSL_5
GB_4:
    s_waitcnt lgkmcnt(7)
    v_mfma_f32_32x32x16_bf16 v[48:63], v[120:123], v[112:115], v[48:63]
    ds_read_b128 v[80:83], v8 offset:28672
    ds_read_b64_tr_b16 v[88:89], v12 offset:29696
    ds_read_b64_tr_b16 v[90:91], v12 offset:29952
    v_mfma_f32_32x32x16_bf16 v[64:79], v[112:115], v[124:127], v[64:79]
    ds_read_b64_tr_b16 v[92:93], v13 offset:30720
    ds_read_b64_tr_b16 v[94:95], v13 offset:30976
    v_mfma_f32_32x32x16_bf16 v[32:47], v[116:119], v[112:115], v[32:47]
    ds_read_b64_tr_b16 v[84:85], v12 offset:28672
    ds_read_b64_tr_b16 v[86:87], v12 offset:28928
    s_waitcnt lgkmcnt(7)
    v_mfma_f32_32x32x16_bf16 v[48:63], v[136:139], v[128:131], v[48:63]
    ds_write_b32 v21, v6
    ds_read_b128 v[96:99], v9 offset:28672
    ds_read_b64_tr_b16 v[104:105], v12 offset:32768
    ds_read_b64_tr_b16 v[106:107], v12 offset:33024
    v_mfma_f32_32x32x16_bf16 v[64:79], v[128:131], v[140:143], v[64:79]
    ds_read_b64_tr_b16 v[108:109], v13 offset:33792
    ds_read_b64_tr_b16 v[110:111], v13 offset:34048
    v_mfma_f32_32x32x16_bf16 v[32:47], v[132:135], v[128:131], v[32:47]
    ds_read_b64_tr_b16 v[100:101], v12 offset:31744
    ds_read_b64_tr_b16 v[102:103], v12 offset:32000
GE_6:
    s_cmp_eq_u32 s59, 1
    s_cbranch_scc1 L_GS_XT
L_GS_XTB:
    s_waitcnt lgkmcnt(8)
    v_mfma_f32_32x32x16_bf16 v[48:63], v[88:91], v[80:83], v[48:63]
    ds_read_b128 v[24:27], v20
    ds_read_b128 v[112:115], v10 offset:28672
    ds_read_b64_tr_b16 v[120:121], v12 offset:35840
    ds_read_b64_tr_b16 v[122:123], v12 offset:36096
    v_mfma_f32_32x32x16_bf16 v[64:79], v[80:83], v[92:95], v[64:79]
    ds_read_b64_tr_b16 v[124:125], v13 offset:36864
    ds_read_b64_tr_b16 v[126:127], v13 offset:37120
    v_mfma_f32_32x32x16_bf16 v[32:47], v[84:87], v[80:83], v[32:47]
    ds_read_b64_tr_b16 v[116:117], v12 offset:34816
    ds_read_b64_tr_b16 v[118:119], v12 offset:35072
    s_add_u32 s58, s57, 3
    s_min_u32 s58, s58, s63
    s_waitcnt lgkmcnt(7)
    v_mfma_f32_32x32x16_bf16 v[48:63], v[104:107], v[96:99], v[48:63]
    ds_read_b128 v[128:131], v11 offset:28672
    ds_read_b64_tr_b16 v[136:137], v12 offset:38912
    ds_read_b64_tr_b16 v[138:139], v12 offset:39168
    v_min3_u32 v24, v24, v25, v26
    v_min_u32 v24, v24, v27
    v_mfma_f32_32x32x16_bf16 v[64:79], v[96:99], v[108:111], v[64:79]
    ds_read_b64_tr_b16 v[140:141], v13 offset:39936
    ds_read_b64_tr_b16 v[142:143], v13 offset:40192
    v_readfirstlane_b32 s64, v24
    v_add_u32 v6, 2, v28
    v_mfma_f32_32x32x16_bf16 v[32:47], v[100:103], v[96:99], v[32:47]
    ds_read_b64_tr_b16 v[132:133], v12 offset:37888
    ds_read_b64_tr_b16 v[134:135], v12 offset:38144
    s_cmp_lt_u32 s64, s58
    s_cbranch_scc1 GSL_8
GB_7:
    s_waitcnt lgkmcnt(7)
    v_mfma_f32_32x32x16_bf16 v[48:63], v[120:123], v[112:115], v[48:63]
    ds_read_b128 v[80:83], v14 offset:0
    ds_read_b64_tr_b16 v[88:89], v18 offset:1024
    ds_read_b64_tr_b16 v[90:91], v18 offset:1280
    v_mfma_f32_32x32x16_bf16 v[64:79], v[112:115], v[124:127], v[64:79]
    ds_read_b64_tr_b16 v[92:93], v19 offset:2048
    ds_read_b64_tr_b16 v[94:95], v19 offset:2304
    v_mfma_f32_32x32x16_bf16 v[32:47], v[116:119], v[112:115], v[32:47]
    ds_read_b64_tr_b16 v[84:85], v18 offset:0
    ds_read_b64_tr_b16 v[86:87], v18 offset:256
    s_waitcnt lgkmcnt(7)
    v_mfma_f32_32x32x16_bf16 v[48:63], v[136:139], v[128:131], v[48:63]
    ds_write_b32 v21, v6
    ds_read_b128 v[96:99], v15 offset:0
    ds_read_b64_tr_b16 v[104:105], v18 offset:4096
    ds_read_b64_tr_b16 v[106:107], v18 offset:4352
    v_mfma_f32_32x32x16_bf16 v[64:79], v[128:131], v[140:143], v[64:79]
    ds_read_b64_tr_b16 v[108:109], v19 offset:5120
    ds_read_b64_tr_b16 v[110:111], v19 offset:5376
    v_mfma_f32_32x32x16_bf16 v[32:47], v[132:135], v[128:131], v[32:47]
    ds_read_b64_tr_b16 v[100:101], v18 offset:3072
    ds_read_b64_tr_b16 v[102:103], v18 offset:3328
GE_9:
    s_waitcnt lgkmcnt(8)
    v_mfma_f32_32x32x16_bf16 v[48:63], v[88:91], v[80:83], v[48:63]
    ds_read_b128 v[24:27], v20
    ds_read_b128 v[112:115], v16 offset:0
    ds_read_b64_tr_b16 v[120:121], v18 offset:7168
    ds_read_b64_tr_b16 v[122:123], v18 offset:7424
    v_mfma_f32_32x32x16_bf16 v[64:79], v[80:83], v[92:95], v[64:79]
    ds_read_b64_tr_b16 v[124:125], v19 offset:8192
    ds_read_b64_tr_b16 v[126:127], v19 offset:8448
    v_mfma_f32_32x32x16_bf16 v[32:47], v[84:87], v[80:83], v[32:47]
    ds_read_b64_tr_b16 v[116:117], v18 offset:6144
    ds_read_b64_tr_b16 v[118:119], v18 offset:6400
    s_add_u32 s58, s57, 4
    s_min_u32 s58, s58, s63
    s_waitcnt lgkmcnt(7)
    v_mfma_f32_32x32x16_bf16 v[48:63], v[104:107], v[96:99], v[48:63]
    ds_read_b128 v[128:131], v17 offset:0
    ds_read_b64_tr_b16 v[136:137], v18 offset:10240
    ds_read_b64_tr_b16 v[138:139], v18 offset:10496
    v_min3_u32 v24, v24, v25, v26
    v_min_u32 v24, v24, v27
    v_mfma_f32_32x32x16_bf16 v[64:79], v[96:99], v[108:111], v[64:79]
    ds_read_b64_tr_b16 v[140:141], v19 offset:11264
    ds_read_b64_tr_b16 v[142:143], v19 offset:11520
    v_readfirstlane_b32 s64, v24
    v_add_u32 v6, 3, v28
    v_mfma_f32_32x32x16_bf16 v[32:47], v[100:103], v[96:99], v[32:47]
    ds_read_b64_tr_b16 v[132:133], v18 offset:9216
    ds_read_b64_tr_b16 v[134:135], v18 offset:9472
    s_cmp_lt_u32 s64, s58
    s_cbranch_scc1 GSL_11
GB_10:
    s_waitcnt lgkmcnt(7)
    v_mfma_f32_32x32x16_bf16 v[48:63], v[120:123], v[112:115], v[48:63]
    ds_read_b128 v[80:83], v14 offset:28672
    ds_read_b64_tr_b16 v[88:89], v18 offset:29696
    ds_read_b64_tr_b16 v[90:91], v18 offset:29952
    v_mfma_f32_32x32x16_bf16 v[64:79], v[112:115], v[124:127], v[64:79]
    ds_read_b64_tr_b16 v[92:93], v19 offset:30720
    ds_read_b64_tr_b16 v[94:95], v19 offset:30976
    v_mfma_f32_32x32x16_bf16 v[32:47], v[116:119], v[112:115], v[32:47]
    ds_read_b64_tr_b16 v[84:85], v18 offset:28672
    ds_read_b64_tr_b16 v[86:87], v18 offset:28928
    s_waitcnt lgkmcnt(7)
    v_mfma_f32_32x32x16_bf16 v[48:63], v[136:139], v[128:131], v[48:63]
    ds_write_b32 v21, v6
    ds_read_b128 v[96:99], v15 offset:28672
    ds_read_b64_tr_b16 v[104:105], v18 offset:32768
    ds_read_b64_tr_b16 v[106:107], v18 offset:33024
    v_mfma_f32_32x32x16_bf16 v[64:79], v[128:131], v[140:143], v[64:79]
    ds_read_b64_tr_b16 v[108:109], v19 offset:33792
    ds_read_b64_tr_b16 v[110:111], v19 offset:34048
    v_mfma_f32_32x32x16_bf16 v[32:47], v[132:135], v[128:131], v[32:47]
    ds_read_b64_tr_b16 v[100:101], v18 offset:31744
    ds_read_b64_tr_b16 v[102:103], v18 offset:32000
GE_12:
    s_waitcnt lgkmcnt(8)
    v_mfma_f32_32x32x16_bf16 v[48:63], v[88:91], v[80:83], v[48:63]
    ds_read_b128 v[24:27], v20
    ds_read_b128 v[112:115], v16 offset:28672
    ds_read_b64_tr_b16 v[120:121], v18 offset:35840
    ds_read_b64_tr_b16 v[122:123], v18 offset:36096
    v_mfma_f32_32x32x16_bf16 v[64:79], v[80:83], v[92:95], v[64:79]
    ds_read_b64_tr_b16 v[124:125], v19 offset:36864
    ds_read_b64_tr_b16 v[126:127], v19 offset:37120
    v_mfma_f32_32x32x16_bf16 v[32:47], v[84:87], v[80:83], v[32:47]
    ds_read_b64_tr_b16 v[116:117], v18 offset:34816
    ds_read_b64_tr_b16 v[118:119], v18 offset:35072
    s_add_u32 s58, s57, 5
    s_min_u32 s58, s58, s63
    s_waitcnt lgkmcnt(7)
    v_mfma_f32_32x32x16_bf16 v[48:63], v[104:107], v[96:99], v[48:63]
    ds_read_b128 v[128:131], v17 offset:28672
    ds_read_b64_tr_b16 v[136:137], v18 offset:38912
    ds_read_b64_tr_b16 v[138:139], v18 offset:39168
    v_min3_u32 v24, v24, v25, v26
    v_min_u32 v24, v24, v27
    v_mfma_f32_32x32x16_bf16 v[64:79], v[96:99], v[108:111], v[64:79]
    ds_read_b64_tr_b16 v[140:141], v19 offset:39936
    ds_read_b64_tr_b16 v[142:143], v19 offset:40192
    v_readfirstlane_b32 s64, v24
    v_add_u32 v6, 4, v28
    v_mfma_f32_32x32x16_bf16 v[32:47], v[100:103], v[96:99], v[32:47]
    ds_read_b64_tr_b16 v[132:133], v18 offset:37888
    ds_read_b64_tr_b16 v[134:135], v18 offset:38144
    s_cmp_lt_u32 s64, s58
    s_cbranch_scc1 GSL_14
GB_13:
    s_waitcnt lgkmcnt(7)
    v_mfma_f32_32x32x16_bf16 v[48:63], v[120:123], v[112:115], v[48:63]
    ds_read_b128 v[80:83], v8 offset:0
    ds_read_b64_tr_b16 v[88:89], v12 offset:1024
    ds_read_b64_tr_b16 v[90:91], v12 offset:1280
    v_mfma_f32_32x32x16_bf16 v[64:79], v[112:115], v[124:127], v[64:79]
    ds_read_b64_tr_b16 v[92:93], v13 offset:2048
    ds_read_b64_tr_b16 v[94:95], v13 offset:2304
    v_mfma_f32_32x32x16_bf16 v[32:47], v[116:119], v[112:115], v[32:47]
    ds_read_b64_tr_b16 v[84:85], v12 offset:0
    ds_read_b64_tr_b16 v[86:87], v12 offset:256
    s_waitcnt lgkmcnt(7)
    v_mfma_f32_32x32x16_bf16 v[48:63], v[136:139], v[128:131], v[48:63]
    ds_write_b32 v21, v6
    ds_read_b128 v[96:99], v9 offset:0
    ds_read_b64_tr_b16 v[104:105], v12 offset:4096
    ds_read_b64_tr_b16 v[106:107], v12 offset:4352
    v_mfma_f32_32x32x16_bf16 v[64:79], v[128:131], v[140:143], v[64:79]
    ds_read_b64_tr_b16 v[108:109], v13 offset:5120
    ds_read_b64_tr_b16 v[110:111], v13 offset:5376
    v_mfma_f32_32x32x16_bf16 v[32:47], v[132:135], v[128:131], v[32:47]
    ds_read_b64_tr_b16 v[100:101], v12 offset:3072
    ds_read_b64_tr_b16 v[102:103], v12 offset:3328
GE_15:
    s_add_u32 s57, s57, 4
    v_mov_b32 v28, 4
    s_mov_b32 s62, 28672
    s_mov_b32 s61, 0
    s_mov_b32 s59, 4
    s_cmp_lt_u32 s57, 8
    s_cbranch_scc1 L_GS
    v_mov_b32 v6, 163364
    v_mov_b32 v7, 1
    s_mov_b64 exec, 1
    ds_add_u32 v6, v7
    s_mov_b64 exec, -1
    s_waitcnt lgkmcnt(0)
    s_setprio 1
    v_lshl_add_u32 v6, v3, 5, v4
    v_lshlrev_b32 v6, 4, v6
    v_lshrrev_b32 v7, 4, v2
    v_lshlrev_b32 v7, 16, v7
    v_lshl_add_u32 v7, v3, 8, v7
    v_and_b32 v8, 15, v2
    v_lshl_add_u32 v7, v8, 4, v7
    s_lshl_b32 s57, s49, 17
    s_lshl_b32 s58, s51, 10
    s_add_u32 s57, s57, s58
    s_add_u32 s59, s57, 2228224
    s_add_u32 s60, s59, 0x10000
    s_add_u32 s61, s57, 4390912
    s_add_u32 s57, s57, 65536
    s_add_u32 s58, s57, 0x10000
    s_mov_b32 s62, 0x3eb8aa3b
    v_cvt_pk_bf16_f32 v88, v48, v49
    v_cvt_pk_bf16_f32 v89, v50, v51
    v_cvt_pk_bf16_f32 v90, v52, v53
    v_cvt_pk_bf16_f32 v91, v54, v55
    v_cvt_pk_bf16_f32 v92, v56, v57
    v_cvt_pk_bf16_f32 v93, v58, v59
    v_cvt_pk_bf16_f32 v94, v60, v61
    v_cvt_pk_bf16_f32 v95, v62, v63
    buffer_store_dwordx4 v[88:91], v6, s[40:43], s59 offen sc1
    buffer_store_dwordx4 v[92:95], v6, s[40:43], s60 offen sc1
    v_cvt_pk_bf16_f32 v96, v64, v65
    v_cvt_pk_bf16_f32 v97, v66, v67
    v_cvt_pk_bf16_f32 v98, v68, v69
    v_cvt_pk_bf16_f32 v99, v70, v71
    v_cvt_pk_bf16_f32 v100, v72, v73
    v_cvt_pk_bf16_f32 v101, v74, v75
    v_cvt_pk_bf16_f32 v102, v76, v77
    v_cvt_pk_bf16_f32 v103, v78, v79
    buffer_store_dwordx4 v[96:99], v7, s[40:43], s61 offen sc1
    buffer_store_dwordx4 v[100:103], v7, s[40:43], s61 offen offset:512 sc1
    v_mov_b32 v8, s62
    v_pk_mul_f32 v[32:33], v[32:33], v[8:9] op_sel:[0,0] op_sel_hi:[1,0]
    v_pk_mul_f32 v[34:35], v[34:35], v[8:9] op_sel:[0,0] op_sel_hi:[1,0]
    v_pk_mul_f32 v[36:37], v[36:37], v[8:9] op_sel:[0,0] op_sel_hi:[1,0]
    v_pk_mul_f32 v[38:39], v[38:39], v[8:9] op_sel:[0,0] op_sel_hi:[1,0]
    v_pk_mul_f32 v[40:41], v[40:41], v[8:9] op_sel:[0,0] op_sel_hi:[1,0]
    v_pk_mul_f32 v[42:43], v[42:43], v[8:9] op_sel:[0,0] op_sel_hi:[1,0]
    v_pk_mul_f32 v[44:45], v[44:45], v[8:9] op_sel:[0,0] op_sel_hi:[1,0]
    v_pk_mul_f32 v[46:47], v[46:47], v[8:9] op_sel:[0,0] op_sel_hi:[1,0]
    v_cvt_pk_bf16_f32 v80, v32, v33
    v_cvt_pk_bf16_f32 v81, v34, v35
    v_cvt_pk_bf16_f32 v82, v36, v37
    v_cvt_pk_bf16_f32 v83, v38, v39
    v_cvt_pk_bf16_f32 v84, v40, v41
    v_cvt_pk_bf16_f32 v85, v42, v43
    v_cvt_pk_bf16_f32 v86, v44, v45
    v_cvt_pk_bf16_f32 v87, v46, v47
    buffer_store_dwordx4 v[80:83], v6, s[40:43], s57 offen sc1
    buffer_store_dwordx4 v[84:87], v6, s[40:43], s58 offen sc1
    v_mov_b32 v8, 163360
    s_mov_b32 s65, 1048576
LW_16:
    ds_read_b32 v9, v8
    s_waitcnt lgkmcnt(0)
    v_readfirstlane_b32 s50, v9
    s_sub_u32 s65, s65, 1
    s_cbranch_scc1 LWD_17
    s_cmp_eq_u32 s50, 0
    s_cbranch_scc0 LWD_17
    s_sleep 1
    s_branch LW_16
LWD_17:
    v_mov_b32 v8, 163396
    v_mov_b32 v9, 1
    s_waitcnt vmcnt(0)
    s_mov_b64 exec, 1
    ds_add_rtn_u32 v9, v8, v9
    s_waitcnt lgkmcnt(0)
    v_readfirstlane_b32 s64, v9
    v_mov_b32 v8, 0
    v_mov_b32 v9, s50
    s_cmp_lg_u32 s64, 3
    s_cbranch_scc1 GF_18
    buffer_store_dword v9, v8, s[40:43], s56 offen sc1
GF_18:
    s_mov_b64 exec, -1
    s_setprio 0
    s_and_b32 s22, s2, 31
    s_lshr_b32 s20, s2, 5
    s_lshl_b32 s20, s20, 2
    s_and_b32 s23, s3, 3
    s_add_u32 s20, s20, s23
    s_lshl_b32 s20, s20, 1
    s_lshr_b32 s21, s3, 2
    s_lshl_b32 s24, s21, 15
    s_lshl_b32 s23, s23, 11
    s_add_u32 s23, s23, 155136
    v_mov_b32 v28, 0xdddd
    v_add_u32 v29, s24, v1
    v_add_u32 v29, 32256, v29
    v_and_b32 v128, 15, v2
    v_lshlrev_b32 v128, 4, v128
    v_lshl_add_u32 v128, v3, 8, v128
    s_add_u32 s24, s24, 97792
    v_add_u32 v30, s24, v128
    v_cmp_eq_u32 vcc, 16, v2
    v_mov_b32 v128, 0x3f803f80
    s_mov_b32 s12, 0xffff
    s_mov_b32 s13, 0xffff
    v_cndmask_b32 v16, 0, v128, vcc
    v_add_u32 v128, s23, v1
    v_mov_b32 v17, v16
    v_mov_b32 v18, v16
    v_mov_b32 v19, v16
    v_mov_b32 v20, v16
    v_mov_b32 v21, v16
    v_mov_b32 v22, v16
    v_mov_b32 v23, v16
    v_mov_b32 v24, v16
    v_mov_b32 v25, v16
    v_mov_b32 v26, v16
    v_mov_b32 v27, v16
    v_mov_b32 v64, 0
    v_mov_b32 v65, 0
    v_mov_b32 v66, 0
    v_mov_b32 v67, 0
    v_mov_b32 v68, 0
    v_mov_b32 v69, 0
    v_mov_b32 v70, 0
    v_mov_b32 v71, 0
    v_mov_b32 v72, 0
    v_mov_b32 v73, 0
    v_mov_b32 v74, 0
    v_mov_b32 v75, 0
    v_mov_b32 v76, 0
    v_mov_b32 v77, 0
    v_mov_b32 v78, 0
    v_mov_b32 v79, 0
    v_mov_b32 v80, 0
    v_mov_b32 v81, 0
    v_mov_b32 v82, 0
    v_mov_b32 v83, 0
    v_mov_b32 v84, 0
    v_mov_b32 v85, 0
    v_mov_b32 v86, 0
    v_mov_b32 v87, 0
    v_mov_b32 v88, 0
    v_mov_b32 v89, 0
    v_mov_b32 v90, 0
    v_mov_b32 v91, 0
    v_mov_b32 v92, 0
    v_mov_b32 v93, 0
    v_mov_b32 v94, 0
    v_mov_b32 v95, 0
    s_mov_b64 s[14:15], -1
    s_mov_b64 s[16:17], s[12:13]
    v_mov_b32 v31, 163328
    v_mov_b32 v131, 1
    s_barrier
L_PRO0:
    ds_read_b128 v[12:15], v29
    ds_read_b128 v[4:7], v128
    ds_read_b128 v[8:11], v128 offset:1024
    s_mov_b64 exec, s[16:17]
    ds_read_b128 v[20:23], v30
    s_mov_b64 exec, s[14:15]
    s_waitcnt lgkmcnt(2)
    v_mfma_f32_32x32x16_bf16 v[32:47], v[12:15], v[4:7], 0
    s_waitcnt lgkmcnt(0)
    v_mfma_f32_32x32x16_bf16 v[48:63], v[12:15], v[8:11], 0
    s_nop 9
    v_max3_f32 v128, v32, v33, v34
    v_max3_f32 v128, v128, v35, v36
    v_max3_f32 v128, v128, v37, v38
    v_max3_f32 v128, v128, v39, v40
    v_max3_f32 v128, v128, v41, v42
    v_max3_f32 v128, v128, v43, v44
    v_max3_f32 v128, v128, v45, v46
    v_max_f32 v128, v128, v47
    v_max3_f32 v129, v48, v49, v50
    v_max3_f32 v129, v129, v51, v52
    v_max3_f32 v129, v129, v53, v54
    v_max3_f32 v129, v129, v55, v56
    v_max3_f32 v129, v129, v57, v58
    v_max3_f32 v129, v129, v59, v60
    v_max3_f32 v129, v129, v61, v62
    v_max_f32 v129, v129, v63
    v_mov_b32 v130, v128
    s_nop 1
    v_permlane32_swap_b32 v128, v130
    v_max_f32 v128, v128, v130
    v_sub_f32 v96, 0, v128
    v_sub_f32 v97, 0, v128
    v_pk_mov_b32 v[98:99], v[96:97], v[96:97] op_sel:[0,1]
    v_pk_mov_b32 v[100:101], v[96:97], v[96:97] op_sel:[0,1]
    v_pk_mov_b32 v[102:103], v[96:97], v[96:97] op_sel:[0,1]
    v_pk_mov_b32 v[104:105], v[96:97], v[96:97] op_sel:[0,1]
    v_pk_mov_b32 v[106:107], v[96:97], v[96:97] op_sel:[0,1]
    v_pk_mov_b32 v[108:109], v[96:97], v[96:97] op_sel:[0,1]
    v_pk_mov_b32 v[110:111], v[96:97], v[96:97] op_sel:[0,1]
    s_nop 1
    v_mfma_f32_32x32x16_bf16 v[32:47], v[12:15], v[4:7], v[96:111]
    v_mov_b32 v130, v129
    s_nop 1
    v_permlane32_swap_b32 v129, v130
    v_max_f32 v129, v129, v130
    v_sub_f32 v112, 0, v129
    v_sub_f32 v113, 0, v129
    v_pk_mov_b32 v[114:115], v[112:113], v[112:113] op_sel:[0,1]
    v_pk_mov_b32 v[116:117], v[112:113], v[112:113] op_sel:[0,1]
    v_pk_mov_b32 v[118:119], v[112:113], v[112:113] op_sel:[0,1]
    v_pk_mov_b32 v[120:121], v[112:113], v[112:113] op_sel:[0,1]
    v_pk_mov_b32 v[122:123], v[112:113], v[112:113] op_sel:[0,1]
    v_pk_mov_b32 v[124:125], v[112:113], v[112:113] op_sel:[0,1]
    v_pk_mov_b32 v[126:127], v[112:113], v[112:113] op_sel:[0,1]
    v_exp_f32 v32, v32
    v_exp_f32 v33, v33
    s_mov_b64 exec, s[12:13]
    ds_read_b128 v[16:19], v30 offset:512
    ds_read_b128 v[24:27], v30 offset:1024
    s_mov_b64 exec, -1
    v_exp_f32 v34, v34
    v_exp_f32 v35, v35
    v_exp_f32 v36, v36
    v_exp_f32 v37, v37
    v_mfma_f32_32x32x16_bf16 v[48:63], v[12:15], v[8:11], v[112:127]
    ds_read_b128 v[12:15], v29 offset:1024
    v_exp_f32 v38, v38
    v_exp_f32 v39, v39
    v_exp_f32 v40, v40
    v_exp_f32 v41, v41
    v_exp_f32 v42, v42
    v_smfmac_f32_32x32x32_bf16 v[64:79], v[20:23], v[32:39], v28
    v_exp_f32 v43, v43
    v_exp_f32 v44, v44
    v_exp_f32 v45, v45
    v_exp_f32 v46, v46
    v_exp_f32 v47, v47
    v_exp_f32 v48, v48
    s_waitcnt lgkmcnt(0)
    v_exp_f32 v49, v49
    v_smfmac_f32_32x32x32_bf16 v[64:79], v[16:19], v[40:47], v28
    v_exp_f32 v50, v50
    v_exp_f32 v51, v51
    v_exp_f32 v52, v52
    v_mfma_f32_32x32x16_bf16 v[32:47], v[12:15], v[4:7], v[96:111]
    v_exp_f32 v53, v53
    v_exp_f32 v54, v54
    v_exp_f32 v55, v55
    v_exp_f32 v56, v56
    v_exp_f32 v57, v57
    v_exp_f32 v58, v58
    v_smfmac_f32_32x32x32_bf16 v[80:95], v[20:23], v[48:55], v28
    v_exp_f32 v59, v59
    v_exp_f32 v60, v60
    v_exp_f32 v61, v61
    v_exp_f32 v62, v62
    v_exp_f32 v63, v63
    s_barrier
    v_exp_f32 v32, v32
    v_exp_f32 v33, v33
    v_smfmac_f32_32x32x32_bf16 v[80:95], v[16:19], v[56:63], v28
    s_mov_b64 exec, s[12:13]
    ds_read_b128 v[16:19], v30 offset:1536
    ds_read_b128 v[20:23], v30 offset:2048
    s_mov_b64 exec, -1
    v_exp_f32 v34, v34
    v_exp_f32 v35, v35
    v_exp_f32 v36, v36
    v_exp_f32 v37, v37
    v_mfma_f32_32x32x16_bf16 v[48:63], v[12:15], v[8:11], v[112:127]
    ds_read_b128 v[12:15], v29 offset:2048
    v_exp_f32 v38, v38
    v_exp_f32 v39, v39
    v_exp_f32 v40, v40
    v_exp_f32 v41, v41
    v_exp_f32 v42, v42
    v_smfmac_f32_32x32x32_bf16 v[64:79], v[24:27], v[32:39], v28
    v_exp_f32 v43, v43
    v_exp_f32 v44, v44
    v_exp_f32 v45, v45
    v_exp_f32 v46, v46
    v_exp_f32 v47, v47
    v_exp_f32 v48, v48
    s_waitcnt lgkmcnt(0)
    v_exp_f32 v49, v49
    v_smfmac_f32_32x32x32_bf16 v[64:79], v[16:19], v[40:47], v28
    v_exp_f32 v50, v50
    v_exp_f32 v51, v51
    v_exp_f32 v52, v52
    v_mfma_f32_32x32x16_bf16 v[32:47], v[12:15], v[4:7], v[96:111]
    v_exp_f32 v53, v53
    v_exp_f32 v54, v54
    v_exp_f32 v55, v55
    v_exp_f32 v56, v56
    v_exp_f32 v57, v57
    v_exp_f32 v58, v58
    v_smfmac_f32_32x32x32_bf16 v[80:95], v[24:27], v[48:55], v28
    v_exp_f32 v59, v59
    v_exp_f32 v60, v60
    v_exp_f32 v61, v61
    v_exp_f32 v62, v62
    v_exp_f32 v63, v63
    v_exp_f32 v32, v32
    v_exp_f32 v33, v33
    v_smfmac_f32_32x32x32_bf16 v[80:95], v[16:19], v[56:63], v28
    s_mov_b64 exec, s[12:13]
    ds_read_b128 v[16:19], v30 offset:2560
    ds_read_b128 v[24:27], v30 offset:3072
    s_mov_b64 exec, -1
    v_exp_f32 v34, v34
    v_exp_f32 v35, v35
    v_exp_f32 v36, v36
    v_exp_f32 v37, v37
    v_mfma_f32_32x32x16_bf16 v[48:63], v[12:15], v[8:11], v[112:127]
    ds_read_b128 v[12:15], v29 offset:3072
    v_exp_f32 v38, v38
    v_exp_f32 v39, v39
    v_exp_f32 v40, v40
    v_exp_f32 v41, v41
    v_exp_f32 v42, v42
    v_smfmac_f32_32x32x32_bf16 v[64:79], v[20:23], v[32:39], v28
    v_exp_f32 v43, v43
    v_exp_f32 v44, v44
    v_exp_f32 v45, v45
    v_exp_f32 v46, v46
    v_exp_f32 v47, v47
    v_exp_f32 v48, v48
    s_waitcnt lgkmcnt(0)
    v_exp_f32 v49, v49
    v_smfmac_f32_32x32x32_bf16 v[64:79], v[16:19], v[40:47], v28
    v_exp_f32 v50, v50
    v_exp_f32 v51, v51
    v_exp_f32 v52, v52
    v_mfma_f32_32x32x16_bf16 v[32:47], v[12:15], v[4:7], v[96:111]
    v_exp_f32 v53, v53
    v_exp_f32 v54, v54
    v_exp_f32 v55, v55
    v_exp_f32 v56, v56
    v_exp_f32 v57, v57
    v_exp_f32 v58, v58
    v_smfmac_f32_32x32x32_bf16 v[80:95], v[20:23], v[48:55], v28
    v_exp_f32 v59, v59
    v_exp_f32 v60, v60
    v_exp_f32 v61, v61
    v_exp_f32 v62, v62
    v_exp_f32 v63, v63
    v_exp_f32 v32, v32
    v_exp_f32 v33, v33
    v_smfmac_f32_32x32x32_bf16 v[80:95], v[16:19], v[56:63], v28
    s_mov_b64 exec, s[12:13]
    ds_read_b128 v[16:19], v30 offset:3584
    ds_read_b128 v[20:23], v30 offset:4096
    s_mov_b64 exec, -1
    v_exp_f32 v34, v34
    v_exp_f32 v35, v35
    v_exp_f32 v36, v36
    v_exp_f32 v37, v37
    v_mfma_f32_32x32x16_bf16 v[48:63], v[12:15], v[8:11], v[112:127]
    ds_read_b128 v[12:15], v29 offset:4096
    v_exp_f32 v38, v38
    v_exp_f32 v39, v39
    v_exp_f32 v40, v40
    v_exp_f32 v41, v41
    v_exp_f32 v42, v42
    v_smfmac_f32_32x32x32_bf16 v[64:79], v[24:27], v[32:39], v28
    v_exp_f32 v43, v43
    v_exp_f32 v44, v44
    v_exp_f32 v45, v45
    v_exp_f32 v46, v46
    v_exp_f32 v47, v47
    v_exp_f32 v48, v48
    s_waitcnt lgkmcnt(0)
    v_exp_f32 v49, v49
    v_smfmac_f32_32x32x32_bf16 v[64:79], v[16:19], v[40:47], v28
    v_exp_f32 v50, v50
    v_exp_f32 v51, v51
    v_exp_f32 v52, v52
    v_mfma_f32_32x32x16_bf16 v[32:47], v[12:15], v[4:7], v[96:111]
    v_exp_f32 v53, v53
    v_exp_f32 v54, v54
    v_exp_f32 v55, v55
    v_exp_f32 v56, v56
    v_exp_f32 v57, v57
    v_exp_f32 v58, v58
    v_smfmac_f32_32x32x32_bf16 v[80:95], v[24:27], v[48:55], v28
    v_exp_f32 v59, v59
    v_exp_f32 v60, v60
    v_exp_f32 v61, v61
    v_exp_f32 v62, v62
    v_exp_f32 v63, v63
    v_exp_f32 v32, v32
    v_exp_f32 v33, v33
    v_smfmac_f32_32x32x32_bf16 v[80:95], v[16:19], v[56:63], v28
    s_mov_b64 exec, s[12:13]
    ds_read_b128 v[16:19], v30 offset:4608
    ds_read_b128 v[24:27], v30 offset:5120
    s_mov_b64 exec, -1
    v_exp_f32 v34, v34
    v_exp_f32 v35, v35
    v_exp_f32 v36, v36
    v_exp_f32 v37, v37
    v_mfma_f32_32x32x16_bf16 v[48:63], v[12:15], v[8:11], v[112:127]
    ds_read_b128 v[12:15], v29 offset:5120
    v_exp_f32 v38, v38
    v_exp_f32 v39, v39
    v_exp_f32 v40, v40
    v_exp_f32 v41, v41
    v_exp_f32 v42, v42
    v_smfmac_f32_32x32x32_bf16 v[64:79], v[20:23], v[32:39], v28
    v_exp_f32 v43, v43
    v_exp_f32 v44, v44
    v_exp_f32 v45, v45
    v_exp_f32 v46, v46
    v_exp_f32 v47, v47
    v_exp_f32 v48, v48
    s_waitcnt lgkmcnt(0)
    v_exp_f32 v49, v49
    v_smfmac_f32_32x32x32_bf16 v[64:79], v[16:19], v[40:47], v28
    v_exp_f32 v50, v50
    v_exp_f32 v51, v51
    v_exp_f32 v52, v52
    v_mfma_f32_32x32x16_bf16 v[32:47], v[12:15], v[4:7], v[96:111]
    v_exp_f32 v53, v53
    v_exp_f32 v54, v54
    v_exp_f32 v55, v55
    v_exp_f32 v56, v56
    v_exp_f32 v57, v57
    v_exp_f32 v58, v58
    v_smfmac_f32_32x32x32_bf16 v[80:95], v[20:23], v[48:55], v28
    v_exp_f32 v59, v59
    v_exp_f32 v60, v60
    v_exp_f32 v61, v61
    v_exp_f32 v62, v62
    v_exp_f32 v63, v63
    v_exp_f32 v32, v32
    v_exp_f32 v33, v33
    v_smfmac_f32_32x32x32_bf16 v[80:95], v[16:19], v[56:63], v28
    s_mov_b64 exec, s[12:13]
    ds_read_b128 v[16:19], v30 offset:5632
    ds_read_b128 v[20:23], v30 offset:6144
    s_mov_b64 exec, -1
    v_exp_f32 v34, v34
    v_exp_f32 v35, v35
    v_exp_f32 v36, v36
    v_exp_f32 v37, v37
    v_mfma_f32_32x32x16_bf16 v[48:63], v[12:15], v[8:11], v[112:127]
    ds_read_b128 v[12:15], v29 offset:6144
    v_exp_f32 v38, v38
    v_exp_f32 v39, v39
    v_exp_f32 v40, v40
    v_exp_f32 v41, v41
    v_exp_f32 v42, v42
    v_smfmac_f32_32x32x32_bf16 v[64:79], v[24:27], v[32:39], v28
    v_exp_f32 v43, v43
    v_exp_f32 v44, v44
    v_exp_f32 v45, v45
    v_exp_f32 v46, v46
    v_exp_f32 v47, v47
    v_exp_f32 v48, v48
    s_waitcnt lgkmcnt(0)
    v_exp_f32 v49, v49
    v_smfmac_f32_32x32x32_bf16 v[64:79], v[16:19], v[40:47], v28
    v_exp_f32 v50, v50
    v_exp_f32 v51, v51
    v_exp_f32 v52, v52
    v_mfma_f32_32x32x16_bf16 v[32:47], v[12:15], v[4:7], v[96:111]
    v_exp_f32 v53, v53
    v_exp_f32 v54, v54
    v_exp_f32 v55, v55
    v_exp_f32 v56, v56
    v_exp_f32 v57, v57
    v_exp_f32 v58, v58
    v_smfmac_f32_32x32x32_bf16 v[80:95], v[24:27], v[48:55], v28
    v_exp_f32 v59, v59
    v_exp_f32 v60, v60
    v_exp_f32 v61, v61
    v_exp_f32 v62, v62
    v_exp_f32 v63, v63
    v_exp_f32 v32, v32
    v_exp_f32 v33, v33
    v_smfmac_f32_32x32x32_bf16 v[80:95], v[16:19], v[56:63], v28
    s_mov_b64 exec, s[12:13]
    ds_read_b128 v[16:19], v30 offset:6656
    ds_read_b128 v[24:27], v30 offset:7168
    s_mov_b64 exec, -1
    v_exp_f32 v34, v34
    v_exp_f32 v35, v35
    v_exp_f32 v36, v36
    v_exp_f32 v37, v37
    v_mfma_f32_32x32x16_bf16 v[48:63], v[12:15], v[8:11], v[112:127]
    ds_read_b128 v[12:15], v29 offset:7168
    v_exp_f32 v38, v38
    v_exp_f32 v39, v39
    v_exp_f32 v40, v40
    v_exp_f32 v41, v41
    v_exp_f32 v42, v42
    v_smfmac_f32_32x32x32_bf16 v[64:79], v[20:23], v[32:39], v28
    v_exp_f32 v43, v43
    v_exp_f32 v44, v44
    v_exp_f32 v45, v45
    v_exp_f32 v46, v46
    v_exp_f32 v47, v47
    v_exp_f32 v48, v48
    s_waitcnt lgkmcnt(0)
    v_exp_f32 v49, v49
    v_smfmac_f32_32x32x32_bf16 v[64:79], v[16:19], v[40:47], v28
    v_exp_f32 v50, v50
    v_exp_f32 v51, v51
    v_exp_f32 v52, v52
    v_mfma_f32_32x32x16_bf16 v[32:47], v[12:15], v[4:7], v[96:111]
    v_exp_f32 v53, v53
    v_exp_f32 v54, v54
    v_exp_f32 v55, v55
    v_exp_f32 v56, v56
    v_exp_f32 v57, v57
    v_exp_f32 v58, v58
    v_smfmac_f32_32x32x32_bf16 v[80:95], v[20:23], v[48:55], v28
    v_exp_f32 v59, v59
    v_exp_f32 v60, v60
    v_exp_f32 v61, v61
    v_exp_f32 v62, v62
    v_exp_f32 v63, v63
    s_barrier
    v_exp_f32 v32, v32
    v_exp_f32 v33, v33
    v_smfmac_f32_32x32x32_bf16 v[80:95], v[16:19], v[56:63], v28
    s_mov_b64 exec, s[12:13]
    ds_read_b128 v[16:19], v30 offset:7680
    ds_read_b128 v[20:23], v30 offset:8192
    s_mov_b64 exec, -1
    v_exp_f32 v34, v34
    v_exp_f32 v35, v35
    v_exp_f32 v36, v36
    v_exp_f32 v37, v37
    v_mfma_f32_32x32x16_bf16 v[48:63], v[12:15], v[8:11], v[112:127]
    ds_read_b128 v[12:15], v29 offset:8192
    v_exp_f32 v38, v38
    v_exp_f32 v39, v39
    v_exp_f32 v40, v40
    v_exp_f32 v41, v41
    v_exp_f32 v42, v42
    v_smfmac_f32_32x32x32_bf16 v[64:79], v[24:27], v[32:39], v28
    v_exp_f32 v43, v43
    v_exp_f32 v44, v44
    v_exp_f32 v45, v45
    v_exp_f32 v46, v46
    v_exp_f32 v47, v47
    v_exp_f32 v48, v48
    s_waitcnt lgkmcnt(0)
    v_exp_f32 v49, v49
    v_smfmac_f32_32x32x32_bf16 v[64:79], v[16:19], v[40:47], v28
    v_exp_f32 v50, v50
    v_exp_f32 v51, v51
    v_exp_f32 v52, v52
    v_mfma_f32_32x32x16_bf16 v[32:47], v[12:15], v[4:7], v[96:111]
    v_exp_f32 v53, v53
    v_exp_f32 v54, v54
    v_exp_f32 v55, v55
    v_exp_f32 v56, v56
    v_exp_f32 v57, v57
    v_exp_f32 v58, v58
    v_smfmac_f32_32x32x32_bf16 v[80:95], v[24:27], v[48:55], v28
    v_exp_f32 v59, v59
    v_exp_f32 v60, v60
    v_exp_f32 v61, v61
    v_exp_f32 v62, v62
    v_exp_f32 v63, v63
    v_exp_f32 v32, v32
    v_exp_f32 v33, v33
    v_smfmac_f32_32x32x32_bf16 v[80:95], v[16:19], v[56:63], v28
    s_mov_b64 exec, s[12:13]
    ds_read_b128 v[16:19], v30 offset:8704
    ds_read_b128 v[24:27], v30 offset:9216
    s_mov_b64 exec, -1
    v_exp_f32 v34, v34
    v_exp_f32 v35, v35
    v_exp_f32 v36, v36
    v_exp_f32 v37, v37
    v_mfma_f32_32x32x16_bf16 v[48:63], v[12:15], v[8:11], v[112:127]
    ds_read_b128 v[12:15], v29 offset:9216
    v_exp_f32 v38, v38
    v_exp_f32 v39, v39
    v_exp_f32 v40, v40
    v_exp_f32 v41, v41
    v_exp_f32 v42, v42
    v_smfmac_f32_32x32x32_bf16 v[64:79], v[20:23], v[32:39], v28
    v_exp_f32 v43, v43
    v_exp_f32 v44, v44
    v_exp_f32 v45, v45
    v_exp_f32 v46, v46
    v_exp_f32 v47, v47
    v_exp_f32 v48, v48
    s_waitcnt lgkmcnt(0)
    v_exp_f32 v49, v49
    v_smfmac_f32_32x32x32_bf16 v[64:79], v[16:19], v[40:47], v28
    v_exp_f32 v50, v50
    v_exp_f32 v51, v51
    v_exp_f32 v52, v52
    v_mfma_f32_32x32x16_bf16 v[32:47], v[12:15], v[4:7], v[96:111]
    v_exp_f32 v53, v53
    v_exp_f32 v54, v54
    v_exp_f32 v55, v55
    v_exp_f32 v56, v56
    v_exp_f32 v57, v57
    v_exp_f32 v58, v58
    v_smfmac_f32_32x32x32_bf16 v[80:95], v[20:23], v[48:55], v28
    v_exp_f32 v59, v59
    v_exp_f32 v60, v60
    v_exp_f32 v61, v61
    v_exp_f32 v62, v62
    v_exp_f32 v63, v63
    v_exp_f32 v32, v32
    v_exp_f32 v33, v33
    v_smfmac_f32_32x32x32_bf16 v[80:95], v[16:19], v[56:63], v28
    s_mov_b64 exec, s[12:13]
    ds_read_b128 v[16:19], v30 offset:9728
    ds_read_b128 v[20:23], v30 offset:10240
    s_mov_b64 exec, -1
    v_exp_f32 v34, v34
    v_exp_f32 v35, v35
    v_exp_f32 v36, v36
    v_exp_f32 v37, v37
    v_mfma_f32_32x32x16_bf16 v[48:63], v[12:15], v[8:11], v[112:127]
    ds_read_b128 v[12:15], v29 offset:10240
    v_exp_f32 v38, v38
    v_exp_f32 v39, v39
    v_exp_f32 v40, v40
    v_exp_f32 v41, v41
    v_exp_f32 v42, v42
    v_smfmac_f32_32x32x32_bf16 v[64:79], v[24:27], v[32:39], v28
    v_exp_f32 v43, v43
    v_exp_f32 v44, v44
    v_exp_f32 v45, v45
    v_exp_f32 v46, v46
    v_exp_f32 v47, v47
    v_exp_f32 v48, v48
    s_waitcnt lgkmcnt(0)
    v_exp_f32 v49, v49
    v_smfmac_f32_32x32x32_bf16 v[64:79], v[16:19], v[40:47], v28
    v_exp_f32 v50, v50
    v_exp_f32 v51, v51
    v_exp_f32 v52, v52
    v_mfma_f32_32x32x16_bf16 v[32:47], v[12:15], v[4:7], v[96:111]
    v_exp_f32 v53, v53
    v_exp_f32 v54, v54
    v_exp_f32 v55, v55
    v_exp_f32 v56, v56
    v_exp_f32 v57, v57
    v_exp_f32 v58, v58
    v_smfmac_f32_32x32x32_bf16 v[80:95], v[24:27], v[48:55], v28
    v_exp_f32 v59, v59
    v_exp_f32 v60, v60
    v_exp_f32 v61, v61
    v_exp_f32 v62, v62
    v_exp_f32 v63, v63
    v_exp_f32 v32, v32
    v_exp_f32 v33, v33
    v_smfmac_f32_32x32x32_bf16 v[80:95], v[16:19], v[56:63], v28
    s_mov_b64 exec, s[12:13]
    ds_read_b128 v[16:19], v30 offset:10752
    ds_read_b128 v[24:27], v30 offset:11264
    s_mov_b64 exec, -1
    v_exp_f32 v34, v34
    v_exp_f32 v35, v35
    v_exp_f32 v36, v36
    v_exp_f32 v37, v37
    v_mfma_f32_32x32x16_bf16 v[48:63], v[12:15], v[8:11], v[112:127]
    ds_read_b128 v[12:15], v29 offset:11264
    v_exp_f32 v38, v38
    v_exp_f32 v39, v39
    v_exp_f32 v40, v40
    v_exp_f32 v41, v41
    v_exp_f32 v42, v42
    v_smfmac_f32_32x32x32_bf16 v[64:79], v[20:23], v[32:39], v28
    v_exp_f32 v43, v43
    v_exp_f32 v44, v44
    v_exp_f32 v45, v45
    v_exp_f32 v46, v46
    v_exp_f32 v47, v47
    v_exp_f32 v48, v48
    s_waitcnt lgkmcnt(0)
    v_exp_f32 v49, v49
    v_smfmac_f32_32x32x32_bf16 v[64:79], v[16:19], v[40:47], v28
    v_exp_f32 v50, v50
    v_exp_f32 v51, v51
    v_exp_f32 v52, v52
    v_mfma_f32_32x32x16_bf16 v[32:47], v[12:15], v[4:7], v[96:111]
    v_exp_f32 v53, v53
    v_exp_f32 v54, v54
    v_exp_f32 v55, v55
    v_exp_f32 v56, v56
    v_exp_f32 v57, v57
    v_exp_f32 v58, v58
    v_smfmac_f32_32x32x32_bf16 v[80:95], v[20:23], v[48:55], v28
    v_exp_f32 v59, v59
    v_exp_f32 v60, v60
    v_exp_f32 v61, v61
    v_exp_f32 v62, v62
    v_exp_f32 v63, v63
    v_exp_f32 v32, v32
    v_exp_f32 v33, v33
    v_smfmac_f32_32x32x32_bf16 v[80:95], v[16:19], v[56:63], v28
    s_mov_b64 exec, s[12:13]
    ds_read_b128 v[16:19], v30 offset:11776
    ds_read_b128 v[20:23], v30 offset:12288
    s_mov_b64 exec, -1
    v_exp_f32 v34, v34
    v_exp_f32 v35, v35
    v_exp_f32 v36, v36
    v_exp_f32 v37, v37
    v_mfma_f32_32x32x16_bf16 v[48:63], v[12:15], v[8:11], v[112:127]
    ds_read_b128 v[12:15], v29 offset:12288
    v_exp_f32 v38, v38
    v_exp_f32 v39, v39
    v_exp_f32 v40, v40
    v_exp_f32 v41, v41
    v_exp_f32 v42, v42
    v_smfmac_f32_32x32x32_bf16 v[64:79], v[24:27], v[32:39], v28
    v_exp_f32 v43, v43
    v_exp_f32 v44, v44
    v_exp_f32 v45, v45
    v_exp_f32 v46, v46
    v_exp_f32 v47, v47
    v_exp_f32 v48, v48
    s_waitcnt lgkmcnt(0)
    v_exp_f32 v49, v49
    v_smfmac_f32_32x32x32_bf16 v[64:79], v[16:19], v[40:47], v28
    v_exp_f32 v50, v50
    v_exp_f32 v51, v51
    v_exp_f32 v52, v52
    v_mfma_f32_32x32x16_bf16 v[32:47], v[12:15], v[4:7], v[96:111]
    v_exp_f32 v53, v53
    v_exp_f32 v54, v54
    v_exp_f32 v55, v55
    v_exp_f32 v56, v56
    v_exp_f32 v57, v57
    v_exp_f32 v58, v58
    v_smfmac_f32_32x32x32_bf16 v[80:95], v[24:27], v[48:55], v28
    v_exp_f32 v59, v59
    v_exp_f32 v60, v60
    v_exp_f32 v61, v61
    v_exp_f32 v62, v62
    v_exp_f32 v63, v63
    v_exp_f32 v32, v32
    v_exp_f32 v33, v33
    v_smfmac_f32_32x32x32_bf16 v[80:95], v[16:19], v[56:63], v28
    s_mov_b64 exec, s[12:13]
    ds_read_b128 v[16:19], v30 offset:12800
    ds_read_b128 v[24:27], v30 offset:13312
    s_mov_b64 exec, -1
    v_exp_f32 v34, v34
    v_exp_f32 v35, v35
    v_exp_f32 v36, v36
    v_exp_f32 v37, v37
    v_mfma_f32_32x32x16_bf16 v[48:63], v[12:15], v[8:11], v[112:127]
    ds_read_b128 v[12:15], v29 offset:13312
    v_exp_f32 v38, v38
    v_exp_f32 v39, v39
    v_exp_f32 v40, v40
    v_exp_f32 v41, v41
    v_exp_f32 v42, v42
    v_smfmac_f32_32x32x32_bf16 v[64:79], v[20:23], v[32:39], v28
    v_exp_f32 v43, v43
    v_exp_f32 v44, v44
    v_exp_f32 v45, v45
    v_exp_f32 v46, v46
    v_exp_f32 v47, v47
    v_exp_f32 v48, v48
    s_waitcnt lgkmcnt(0)
    v_exp_f32 v49, v49
    v_smfmac_f32_32x32x32_bf16 v[64:79], v[16:19], v[40:47], v28
    v_exp_f32 v50, v50
    v_exp_f32 v51, v51
    v_exp_f32 v52, v52
    v_mfma_f32_32x32x16_bf16 v[32:47], v[12:15], v[4:7], v[96:111]
    v_exp_f32 v53, v53
    v_exp_f32 v54, v54
    v_exp_f32 v55, v55
    v_exp_f32 v56, v56
    v_exp_f32 v57, v57
    v_exp_f32 v58, v58
    v_smfmac_f32_32x32x32_bf16 v[80:95], v[20:23], v[48:55], v28
    v_exp_f32 v59, v59
    v_exp_f32 v60, v60
    v_exp_f32 v61, v61
    v_exp_f32 v62, v62
    v_exp_f32 v63, v63
    v_exp_f32 v32, v32
    v_exp_f32 v33, v33
    v_smfmac_f32_32x32x32_bf16 v[80:95], v[16:19], v[56:63], v28
    s_mov_b64 exec, s[12:13]
    ds_read_b128 v[16:19], v30 offset:13824
    ds_read_b128 v[20:23], v30 offset:14336
    s_mov_b64 exec, -1
    v_exp_f32 v34, v34
    v_exp_f32 v35, v35
    v_exp_f32 v36, v36
    v_exp_f32 v37, v37
    v_mfma_f32_32x32x16_bf16 v[48:63], v[12:15], v[8:11], v[112:127]
    ds_read_b128 v[12:15], v29 offset:14336
    v_exp_f32 v38, v38
    v_exp_f32 v39, v39
    v_exp_f32 v40, v40
    v_exp_f32 v41, v41
    v_exp_f32 v42, v42
    v_smfmac_f32_32x32x32_bf16 v[64:79], v[24:27], v[32:39], v28
    v_exp_f32 v43, v43
    v_exp_f32 v44, v44
    v_exp_f32 v45, v45
    v_exp_f32 v46, v46
    v_exp_f32 v47, v47
    v_exp_f32 v48, v48
    s_waitcnt lgkmcnt(0)
    v_exp_f32 v49, v49
    v_smfmac_f32_32x32x32_bf16 v[64:79], v[16:19], v[40:47], v28
    v_exp_f32 v50, v50
    v_exp_f32 v51, v51
    v_exp_f32 v52, v52
    v_mfma_f32_32x32x16_bf16 v[32:47], v[12:15], v[4:7], v[96:111]
    v_exp_f32 v53, v53
    v_exp_f32 v54, v54
    v_exp_f32 v55, v55
    v_exp_f32 v56, v56
    v_exp_f32 v57, v57
    v_exp_f32 v58, v58
    v_smfmac_f32_32x32x32_bf16 v[80:95], v[24:27], v[48:55], v28
    v_exp_f32 v59, v59
    v_exp_f32 v60, v60
    v_exp_f32 v61, v61
    v_exp_f32 v62, v62
    v_exp_f32 v63, v63
    v_exp_f32 v32, v32
    v_exp_f32 v33, v33
    v_smfmac_f32_32x32x32_bf16 v[80:95], v[16:19], v[56:63], v28
    s_mov_b64 exec, s[12:13]
    ds_read_b128 v[16:19], v30 offset:14848
    ds_read_b128 v[24:27], v30 offset:15360
    s_mov_b64 exec, -1
    v_exp_f32 v34, v34
    v_exp_f32 v35, v35
    v_exp_f32 v36, v36
    v_exp_f32 v37, v37
    v_mfma_f32_32x32x16_bf16 v[48:63], v[12:15], v[8:11], v[112:127]
    ds_read_b128 v[12:15], v29 offset:15360
    v_exp_f32 v38, v38
    v_exp_f32 v39, v39
    v_exp_f32 v40, v40
    v_exp_f32 v41, v41
    v_exp_f32 v42, v42
    v_smfmac_f32_32x32x32_bf16 v[64:79], v[20:23], v[32:39], v28
    v_exp_f32 v43, v43
    v_exp_f32 v44, v44
    v_exp_f32 v45, v45
    v_exp_f32 v46, v46
    v_exp_f32 v47, v47
    v_exp_f32 v48, v48
    s_waitcnt lgkmcnt(0)
    v_exp_f32 v49, v49
    v_smfmac_f32_32x32x32_bf16 v[64:79], v[16:19], v[40:47], v28
    v_exp_f32 v50, v50
    v_exp_f32 v51, v51
    v_exp_f32 v52, v52
    v_mfma_f32_32x32x16_bf16 v[32:47], v[12:15], v[4:7], v[96:111]
    v_exp_f32 v53, v53
    v_exp_f32 v54, v54
    v_exp_f32 v55, v55
    v_exp_f32 v56, v56
    v_exp_f32 v57, v57
    v_exp_f32 v58, v58
    v_smfmac_f32_32x32x32_bf16 v[80:95], v[20:23], v[48:55], v28
    v_exp_f32 v59, v59
    v_exp_f32 v60, v60
    v_exp_f32 v61, v61
    v_exp_f32 v62, v62
    v_exp_f32 v63, v63
    v_exp_f32 v32, v32
    v_exp_f32 v33, v33
    v_smfmac_f32_32x32x32_bf16 v[80:95], v[16:19], v[56:63], v28
    s_mov_b64 exec, s[12:13]
    ds_read_b128 v[16:19], v30 offset:15872
    ds_read_b128 v[20:23], v30 offset:16384
    s_mov_b64 exec, -1
    v_exp_f32 v34, v34
    v_exp_f32 v35, v35
    v_exp_f32 v36, v36
    v_exp_f32 v37, v37
    v_mfma_f32_32x32x16_bf16 v[48:63], v[12:15], v[8:11], v[112:127]
    ds_read_b128 v[12:15], v29 offset:16384
    v_exp_f32 v38, v38
    v_exp_f32 v39, v39
    v_exp_f32 v40, v40
    v_exp_f32 v41, v41
    v_exp_f32 v42, v42
    v_smfmac_f32_32x32x32_bf16 v[64:79], v[24:27], v[32:39], v28
    v_exp_f32 v43, v43
    v_exp_f32 v44, v44
    v_exp_f32 v45, v45
    v_exp_f32 v46, v46
    v_exp_f32 v47, v47
    v_exp_f32 v48, v48
    s_waitcnt lgkmcnt(0)
    v_exp_f32 v49, v49
    v_smfmac_f32_32x32x32_bf16 v[64:79], v[16:19], v[40:47], v28
    v_exp_f32 v50, v50
    v_exp_f32 v51, v51
    v_exp_f32 v52, v52
    v_mfma_f32_32x32x16_bf16 v[32:47], v[12:15], v[4:7], v[96:111]
    v_exp_f32 v53, v53
    v_exp_f32 v54, v54
    v_exp_f32 v55, v55
    v_exp_f32 v56, v56
    v_exp_f32 v57, v57
    v_exp_f32 v58, v58
    v_smfmac_f32_32x32x32_bf16 v[80:95], v[24:27], v[48:55], v28
    v_exp_f32 v59, v59
    v_exp_f32 v60, v60
    v_exp_f32 v61, v61
    v_exp_f32 v62, v62
    v_exp_f32 v63, v63
    v_exp_f32 v32, v32
    v_exp_f32 v33, v33
    v_smfmac_f32_32x32x32_bf16 v[80:95], v[16:19], v[56:63], v28
    s_mov_b64 exec, s[12:13]
    ds_read_b128 v[16:19], v30 offset:16896
    ds_read_b128 v[24:27], v30 offset:17408
    s_mov_b64 exec, -1
    v_exp_f32 v34, v34
    v_exp_f32 v35, v35
    v_exp_f32 v36, v36
    v_exp_f32 v37, v37
    v_mfma_f32_32x32x16_bf16 v[48:63], v[12:15], v[8:11], v[112:127]
    ds_read_b128 v[12:15], v29 offset:17408
    v_exp_f32 v38, v38
    v_exp_f32 v39, v39
    v_exp_f32 v40, v40
    v_exp_f32 v41, v41
    v_exp_f32 v42, v42
    v_smfmac_f32_32x32x32_bf16 v[64:79], v[20:23], v[32:39], v28
    v_exp_f32 v43, v43
    v_exp_f32 v44, v44
    v_exp_f32 v45, v45
    v_exp_f32 v46, v46
    v_exp_f32 v47, v47
    v_exp_f32 v48, v48
    s_waitcnt lgkmcnt(0)
    v_exp_f32 v49, v49
    v_smfmac_f32_32x32x32_bf16 v[64:79], v[16:19], v[40:47], v28
    v_exp_f32 v50, v50
    v_exp_f32 v51, v51
    v_exp_f32 v52, v52
    v_mfma_f32_32x32x16_bf16 v[32:47], v[12:15], v[4:7], v[96:111]
    v_exp_f32 v53, v53
    v_exp_f32 v54, v54
    v_exp_f32 v55, v55
    v_exp_f32 v56, v56
    v_exp_f32 v57, v57
    v_exp_f32 v58, v58
    v_smfmac_f32_32x32x32_bf16 v[80:95], v[20:23], v[48:55], v28
    v_exp_f32 v59, v59
    v_exp_f32 v60, v60
    v_exp_f32 v61, v61
    v_exp_f32 v62, v62
    v_exp_f32 v63, v63
    v_exp_f32 v32, v32
    v_exp_f32 v33, v33
    v_smfmac_f32_32x32x32_bf16 v[80:95], v[16:19], v[56:63], v28
    s_mov_b64 exec, s[12:13]
    ds_read_b128 v[16:19], v30 offset:17920
    ds_read_b128 v[20:23], v30 offset:18432
    s_mov_b64 exec, -1
    v_exp_f32 v34, v34
    v_exp_f32 v35, v35
    v_exp_f32 v36, v36
    v_exp_f32 v37, v37
    v_mfma_f32_32x32x16_bf16 v[48:63], v[12:15], v[8:11], v[112:127]
    ds_read_b128 v[12:15], v29 offset:18432
    v_exp_f32 v38, v38
    v_exp_f32 v39, v39
    v_exp_f32 v40, v40
    v_exp_f32 v41, v41
    v_exp_f32 v42, v42
    v_smfmac_f32_32x32x32_bf16 v[64:79], v[24:27], v[32:39], v28
    v_exp_f32 v43, v43
    v_exp_f32 v44, v44
    v_exp_f32 v45, v45
    v_exp_f32 v46, v46
    v_exp_f32 v47, v47
    v_exp_f32 v48, v48
    s_waitcnt lgkmcnt(0)
    v_exp_f32 v49, v49
    v_smfmac_f32_32x32x32_bf16 v[64:79], v[16:19], v[40:47], v28
    v_exp_f32 v50, v50
    v_exp_f32 v51, v51
    v_exp_f32 v52, v52
    v_mfma_f32_32x32x16_bf16 v[32:47], v[12:15], v[4:7], v[96:111]
    v_exp_f32 v53, v53
    v_exp_f32 v54, v54
    v_exp_f32 v55, v55
    v_exp_f32 v56, v56
    v_exp_f32 v57, v57
    v_exp_f32 v58, v58
    v_smfmac_f32_32x32x32_bf16 v[80:95], v[24:27], v[48:55], v28
    v_exp_f32 v59, v59
    v_exp_f32 v60, v60
    v_exp_f32 v61, v61
    v_exp_f32 v62, v62
    v_exp_f32 v63, v63
    v_exp_f32 v32, v32
    v_exp_f32 v33, v33
    v_smfmac_f32_32x32x32_bf16 v[80:95], v[16:19], v[56:63], v28
    s_mov_b64 exec, s[12:13]
    ds_read_b128 v[16:19], v30 offset:18944
    ds_read_b128 v[24:27], v30 offset:19456
    s_mov_b64 exec, -1
    v_exp_f32 v34, v34
    v_exp_f32 v35, v35
    v_exp_f32 v36, v36
    v_exp_f32 v37, v37
    v_mfma_f32_32x32x16_bf16 v[48:63], v[12:15], v[8:11], v[112:127]
    ds_read_b128 v[12:15], v29 offset:19456
    v_exp_f32 v38, v38
    v_exp_f32 v39, v39
    v_exp_f32 v40, v40
    v_exp_f32 v41, v41
    v_exp_f32 v42, v42
    v_smfmac_f32_32x32x32_bf16 v[64:79], v[20:23], v[32:39], v28
    v_exp_f32 v43, v43
    v_exp_f32 v44, v44
    v_exp_f32 v45, v45
    v_exp_f32 v46, v46
    v_exp_f32 v47, v47
    v_exp_f32 v48, v48
    s_waitcnt lgkmcnt(0)
    v_exp_f32 v49, v49
    v_smfmac_f32_32x32x32_bf16 v[64:79], v[16:19], v[40:47], v28
    v_exp_f32 v50, v50
    v_exp_f32 v51, v51
    v_exp_f32 v52, v52
    v_mfma_f32_32x32x16_bf16 v[32:47], v[12:15], v[4:7], v[96:111]
    v_exp_f32 v53, v53
    v_exp_f32 v54, v54
    v_exp_f32 v55, v55
    v_exp_f32 v56, v56
    v_exp_f32 v57, v57
    v_exp_f32 v58, v58
    v_smfmac_f32_32x32x32_bf16 v[80:95], v[20:23], v[48:55], v28
    v_exp_f32 v59, v59
    v_exp_f32 v60, v60
    v_exp_f32 v61, v61
    v_exp_f32 v62, v62
    v_exp_f32 v63, v63
    v_exp_f32 v32, v32
    v_exp_f32 v33, v33
    v_smfmac_f32_32x32x32_bf16 v[80:95], v[16:19], v[56:63], v28
    s_mov_b64 exec, s[12:13]
    ds_read_b128 v[16:19], v30 offset:19968
    ds_read_b128 v[20:23], v30 offset:20480
    s_mov_b64 exec, -1
    v_exp_f32 v34, v34
    v_exp_f32 v35, v35
    v_exp_f32 v36, v36
    v_exp_f32 v37, v37
    v_mfma_f32_32x32x16_bf16 v[48:63], v[12:15], v[8:11], v[112:127]
    ds_read_b128 v[12:15], v29 offset:20480
    v_exp_f32 v38, v38
    v_exp_f32 v39, v39
    v_exp_f32 v40, v40
    v_exp_f32 v41, v41
    v_exp_f32 v42, v42
    v_smfmac_f32_32x32x32_bf16 v[64:79], v[24:27], v[32:39], v28
    v_exp_f32 v43, v43
    v_exp_f32 v44, v44
    v_exp_f32 v45, v45
    v_exp_f32 v46, v46
    v_exp_f32 v47, v47
    v_exp_f32 v48, v48
    s_waitcnt lgkmcnt(0)
    v_exp_f32 v49, v49
    v_smfmac_f32_32x32x32_bf16 v[64:79], v[16:19], v[40:47], v28
    v_exp_f32 v50, v50
    v_exp_f32 v51, v51
    v_exp_f32 v52, v52
    v_mfma_f32_32x32x16_bf16 v[32:47], v[12:15], v[4:7], v[96:111]
    v_exp_f32 v53, v53
    v_exp_f32 v54, v54
    v_exp_f32 v55, v55
    v_exp_f32 v56, v56
    v_exp_f32 v57, v57
    v_exp_f32 v58, v58
    v_smfmac_f32_32x32x32_bf16 v[80:95], v[24:27], v[48:55], v28
    v_exp_f32 v59, v59
    v_exp_f32 v60, v60
    v_exp_f32 v61, v61
    v_exp_f32 v62, v62
    v_exp_f32 v63, v63
    v_exp_f32 v32, v32
    v_exp_f32 v33, v33
    v_smfmac_f32_32x32x32_bf16 v[80:95], v[16:19], v[56:63], v28
    s_mov_b64 exec, s[12:13]
    ds_read_b128 v[16:19], v30 offset:20992
    ds_read_b128 v[24:27], v30 offset:21504
    s_mov_b64 exec, -1
    v_exp_f32 v34, v34
    v_exp_f32 v35, v35
    v_exp_f32 v36, v36
    v_exp_f32 v37, v37
    v_mfma_f32_32x32x16_bf16 v[48:63], v[12:15], v[8:11], v[112:127]
    ds_read_b128 v[12:15], v29 offset:21504
    v_exp_f32 v38, v38
    v_exp_f32 v39, v39
    v_exp_f32 v40, v40
    v_exp_f32 v41, v41
    v_exp_f32 v42, v42
    v_smfmac_f32_32x32x32_bf16 v[64:79], v[20:23], v[32:39], v28
    v_exp_f32 v43, v43
    v_exp_f32 v44, v44
    v_exp_f32 v45, v45
    v_exp_f32 v46, v46
    v_exp_f32 v47, v47
    v_exp_f32 v48, v48
    s_waitcnt lgkmcnt(0)
    v_exp_f32 v49, v49
    v_smfmac_f32_32x32x32_bf16 v[64:79], v[16:19], v[40:47], v28
    v_exp_f32 v50, v50
    v_exp_f32 v51, v51
    v_exp_f32 v52, v52
    v_mfma_f32_32x32x16_bf16 v[32:47], v[12:15], v[4:7], v[96:111]
    v_exp_f32 v53, v53
    v_exp_f32 v54, v54
    v_exp_f32 v55, v55
    v_exp_f32 v56, v56
    v_exp_f32 v57, v57
    v_exp_f32 v58, v58
    v_smfmac_f32_32x32x32_bf16 v[80:95], v[20:23], v[48:55], v28
    v_exp_f32 v59, v59
    v_exp_f32 v60, v60
    v_exp_f32 v61, v61
    v_exp_f32 v62, v62
    v_exp_f32 v63, v63
    v_exp_f32 v32, v32
    v_exp_f32 v33, v33
    v_smfmac_f32_32x32x32_bf16 v[80:95], v[16:19], v[56:63], v28
    s_mov_b64 exec, s[12:13]
    ds_read_b128 v[16:19], v30 offset:22016
    ds_read_b128 v[20:23], v30 offset:22528
    s_mov_b64 exec, -1
    v_exp_f32 v34, v34
    v_exp_f32 v35, v35
    v_exp_f32 v36, v36
    v_exp_f32 v37, v37
    v_mfma_f32_32x32x16_bf16 v[48:63], v[12:15], v[8:11], v[112:127]
    ds_read_b128 v[12:15], v29 offset:22528
    v_exp_f32 v38, v38
    v_exp_f32 v39, v39
    v_exp_f32 v40, v40
    v_exp_f32 v41, v41
    v_exp_f32 v42, v42
    v_smfmac_f32_32x32x32_bf16 v[64:79], v[24:27], v[32:39], v28
    v_exp_f32 v43, v43
    v_exp_f32 v44, v44
    v_exp_f32 v45, v45
    v_exp_f32 v46, v46
    v_exp_f32 v47, v47
    v_exp_f32 v48, v48
    s_waitcnt lgkmcnt(0)
    v_exp_f32 v49, v49
    v_smfmac_f32_32x32x32_bf16 v[64:79], v[16:19], v[40:47], v28
    v_exp_f32 v50, v50
    v_exp_f32 v51, v51
    v_exp_f32 v52, v52
    v_mfma_f32_32x32x16_bf16 v[32:47], v[12:15], v[4:7], v[96:111]
    v_exp_f32 v53, v53
    v_exp_f32 v54, v54
    v_exp_f32 v55, v55
    v_exp_f32 v56, v56
    v_exp_f32 v57, v57
    v_exp_f32 v58, v58
    v_smfmac_f32_32x32x32_bf16 v[80:95], v[24:27], v[48:55], v28
    v_exp_f32 v59, v59
    v_exp_f32 v60, v60
    v_exp_f32 v61, v61
    v_exp_f32 v62, v62
    v_exp_f32 v63, v63
    v_exp_f32 v32, v32
    v_exp_f32 v33, v33
    v_smfmac_f32_32x32x32_bf16 v[80:95], v[16:19], v[56:63], v28
    s_mov_b64 exec, s[12:13]
    ds_read_b128 v[16:19], v30 offset:23040
    ds_read_b128 v[24:27], v30 offset:23552
    s_mov_b64 exec, -1
    v_exp_f32 v34, v34
    v_exp_f32 v35, v35
    v_exp_f32 v36, v36
    v_exp_f32 v37, v37
    v_mfma_f32_32x32x16_bf16 v[48:63], v[12:15], v[8:11], v[112:127]
    ds_read_b128 v[12:15], v29 offset:23552
    v_exp_f32 v38, v38
    v_exp_f32 v39, v39
    v_exp_f32 v40, v40
    v_exp_f32 v41, v41
    v_exp_f32 v42, v42
    v_smfmac_f32_32x32x32_bf16 v[64:79], v[20:23], v[32:39], v28
    v_exp_f32 v43, v43
    v_exp_f32 v44, v44
    v_exp_f32 v45, v45
    v_exp_f32 v46, v46
    v_exp_f32 v47, v47
    v_exp_f32 v48, v48
    s_waitcnt lgkmcnt(0)
    v_exp_f32 v49, v49
    v_smfmac_f32_32x32x32_bf16 v[64:79], v[16:19], v[40:47], v28
    v_exp_f32 v50, v50
    v_exp_f32 v51, v51
    v_exp_f32 v52, v52
    v_mfma_f32_32x32x16_bf16 v[32:47], v[12:15], v[4:7], v[96:111]
    v_exp_f32 v53, v53
    v_exp_f32 v54, v54
    v_exp_f32 v55, v55
    v_exp_f32 v56, v56
    v_exp_f32 v57, v57
    v_exp_f32 v58, v58
    v_smfmac_f32_32x32x32_bf16 v[80:95], v[20:23], v[48:55], v28
    v_exp_f32 v59, v59
    v_exp_f32 v60, v60
    v_exp_f32 v61, v61
    v_exp_f32 v62, v62
    v_exp_f32 v63, v63
    v_exp_f32 v32, v32
    v_exp_f32 v33, v33
    v_smfmac_f32_32x32x32_bf16 v[80:95], v[16:19], v[56:63], v28
    s_mov_b64 exec, s[12:13]
    ds_read_b128 v[16:19], v30 offset:24064
    ds_read_b128 v[20:23], v30 offset:24576
    s_mov_b64 exec, -1
    v_exp_f32 v34, v34
    v_exp_f32 v35, v35
    v_exp_f32 v36, v36
    v_exp_f32 v37, v37
    v_mfma_f32_32x32x16_bf16 v[48:63], v[12:15], v[8:11], v[112:127]
    ds_read_b128 v[12:15], v29 offset:24576
    v_exp_f32 v38, v38
    v_exp_f32 v39, v39
    v_exp_f32 v40, v40
    v_exp_f32 v41, v41
    v_exp_f32 v42, v42
    v_smfmac_f32_32x32x32_bf16 v[64:79], v[24:27], v[32:39], v28
    v_exp_f32 v43, v43
    v_exp_f32 v44, v44
    v_exp_f32 v45, v45
    v_exp_f32 v46, v46
    v_exp_f32 v47, v47
    v_exp_f32 v48, v48
    s_waitcnt lgkmcnt(0)
    v_exp_f32 v49, v49
    v_smfmac_f32_32x32x32_bf16 v[64:79], v[16:19], v[40:47], v28
    v_exp_f32 v50, v50
    v_exp_f32 v51, v51
    v_exp_f32 v52, v52
    v_mfma_f32_32x32x16_bf16 v[32:47], v[12:15], v[4:7], v[96:111]
    v_exp_f32 v53, v53
    v_exp_f32 v54, v54
    v_exp_f32 v55, v55
    v_exp_f32 v56, v56
    v_exp_f32 v57, v57
    v_exp_f32 v58, v58
    v_smfmac_f32_32x32x32_bf16 v[80:95], v[24:27], v[48:55], v28
    v_exp_f32 v59, v59
    v_exp_f32 v60, v60
    v_exp_f32 v61, v61
    v_exp_f32 v62, v62
    v_exp_f32 v63, v63
    v_exp_f32 v32, v32
    v_exp_f32 v33, v33
    v_smfmac_f32_32x32x32_bf16 v[80:95], v[16:19], v[56:63], v28
    s_mov_b64 exec, s[12:13]
    ds_read_b128 v[16:19], v30 offset:25088
    ds_read_b128 v[24:27], v30 offset:25600
    s_mov_b64 exec, -1
    v_exp_f32 v34, v34
    v_exp_f32 v35, v35
    v_exp_f32 v36, v36
    v_exp_f32 v37, v37
    v_mfma_f32_32x32x16_bf16 v[48:63], v[12:15], v[8:11], v[112:127]
    ds_read_b128 v[12:15], v29 offset:25600
    v_exp_f32 v38, v38
    v_exp_f32 v39, v39
    v_exp_f32 v40, v40
    v_exp_f32 v41, v41
    v_exp_f32 v42, v42
    v_smfmac_f32_32x32x32_bf16 v[64:79], v[20:23], v[32:39], v28
    v_exp_f32 v43, v43
    v_exp_f32 v44, v44
    v_exp_f32 v45, v45
    v_exp_f32 v46, v46
    v_exp_f32 v47, v47
    v_exp_f32 v48, v48
    s_waitcnt lgkmcnt(0)
    v_exp_f32 v49, v49
    v_smfmac_f32_32x32x32_bf16 v[64:79], v[16:19], v[40:47], v28
    v_exp_f32 v50, v50
    v_exp_f32 v51, v51
    v_exp_f32 v52, v52
    v_mfma_f32_32x32x16_bf16 v[32:47], v[12:15], v[4:7], v[96:111]
    v_exp_f32 v53, v53
    v_exp_f32 v54, v54
    v_exp_f32 v55, v55
    v_exp_f32 v56, v56
    v_exp_f32 v57, v57
    v_exp_f32 v58, v58
    v_smfmac_f32_32x32x32_bf16 v[80:95], v[20:23], v[48:55], v28
    v_exp_f32 v59, v59
    v_exp_f32 v60, v60
    v_exp_f32 v61, v61
    v_exp_f32 v62, v62
    v_exp_f32 v63, v63
    v_exp_f32 v32, v32
    v_exp_f32 v33, v33
    v_smfmac_f32_32x32x32_bf16 v[80:95], v[16:19], v[56:63], v28
    s_mov_b64 exec, s[12:13]
    ds_read_b128 v[16:19], v30 offset:26112
    ds_read_b128 v[20:23], v30 offset:26624
    s_mov_b64 exec, -1
    v_exp_f32 v34, v34
    v_exp_f32 v35, v35
    v_exp_f32 v36, v36
    v_exp_f32 v37, v37
    v_mfma_f32_32x32x16_bf16 v[48:63], v[12:15], v[8:11], v[112:127]
    ds_read_b128 v[12:15], v29 offset:26624
    v_exp_f32 v38, v38
    v_exp_f32 v39, v39
    v_exp_f32 v40, v40
    v_exp_f32 v41, v41
    v_exp_f32 v42, v42
    v_smfmac_f32_32x32x32_bf16 v[64:79], v[24:27], v[32:39], v28
    v_exp_f32 v43, v43
    v_exp_f32 v44, v44
    v_exp_f32 v45, v45
    v_exp_f32 v46, v46
    v_exp_f32 v47, v47
    v_exp_f32 v48, v48
    s_waitcnt lgkmcnt(0)
    v_exp_f32 v49, v49
    v_smfmac_f32_32x32x32_bf16 v[64:79], v[16:19], v[40:47], v28
    v_exp_f32 v50, v50
    v_exp_f32 v51, v51
    v_exp_f32 v52, v52
    v_mfma_f32_32x32x16_bf16 v[32:47], v[12:15], v[4:7], v[96:111]
    v_exp_f32 v53, v53
    v_exp_f32 v54, v54
    v_exp_f32 v55, v55
    v_exp_f32 v56, v56
    v_exp_f32 v57, v57
    v_exp_f32 v58, v58
    v_smfmac_f32_32x32x32_bf16 v[80:95], v[24:27], v[48:55], v28
    v_exp_f32 v59, v59
    v_exp_f32 v60, v60
    v_exp_f32 v61, v61
    v_exp_f32 v62, v62
    v_exp_f32 v63, v63
    v_exp_f32 v32, v32
    v_exp_f32 v33, v33
    v_smfmac_f32_32x32x32_bf16 v[80:95], v[16:19], v[56:63], v28
    s_mov_b64 exec, s[12:13]
    ds_read_b128 v[16:19], v30 offset:27136
    ds_read_b128 v[24:27], v30 offset:27648
    s_mov_b64 exec, -1
    v_exp_f32 v34, v34
    v_exp_f32 v35, v35
    v_exp_f32 v36, v36
    v_exp_f32 v37, v37
    v_mfma_f32_32x32x16_bf16 v[48:63], v[12:15], v[8:11], v[112:127]
    ds_read_b128 v[12:15], v29 offset:27648
    v_exp_f32 v38, v38
    v_exp_f32 v39, v39
    v_exp_f32 v40, v40
    v_exp_f32 v41, v41
    v_exp_f32 v42, v42
    v_smfmac_f32_32x32x32_bf16 v[64:79], v[20:23], v[32:39], v28
    v_exp_f32 v43, v43
    v_exp_f32 v44, v44
    v_exp_f32 v45, v45
    v_exp_f32 v46, v46
    v_exp_f32 v47, v47
    v_exp_f32 v48, v48
    s_waitcnt lgkmcnt(0)
    v_exp_f32 v49, v49
    v_smfmac_f32_32x32x32_bf16 v[64:79], v[16:19], v[40:47], v28
    v_exp_f32 v50, v50
    v_exp_f32 v51, v51
    v_exp_f32 v52, v52
    v_mfma_f32_32x32x16_bf16 v[32:47], v[12:15], v[4:7], v[96:111]
    v_exp_f32 v53, v53
    v_exp_f32 v54, v54
    v_exp_f32 v55, v55
    v_exp_f32 v56, v56
    v_exp_f32 v57, v57
    v_exp_f32 v58, v58
    v_smfmac_f32_32x32x32_bf16 v[80:95], v[20:23], v[48:55], v28
    v_exp_f32 v59, v59
    v_exp_f32 v60, v60
    v_exp_f32 v61, v61
    v_exp_f32 v62, v62
    v_exp_f32 v63, v63
    v_exp_f32 v32, v32
    v_exp_f32 v33, v33
    v_smfmac_f32_32x32x32_bf16 v[80:95], v[16:19], v[56:63], v28
    s_mov_b64 exec, s[12:13]
    ds_read_b128 v[16:19], v30 offset:28160
    ds_read_b128 v[20:23], v30 offset:28672
    s_mov_b64 exec, -1
    v_exp_f32 v34, v34
    v_exp_f32 v35, v35
    v_exp_f32 v36, v36
    v_exp_f32 v37, v37
    v_mfma_f32_32x32x16_bf16 v[48:63], v[12:15], v[8:11], v[112:127]
    ds_read_b128 v[12:15], v29 offset:28672
    v_exp_f32 v38, v38
    v_exp_f32 v39, v39
    v_exp_f32 v40, v40
    v_exp_f32 v41, v41
    v_exp_f32 v42, v42
    v_smfmac_f32_32x32x32_bf16 v[64:79], v[24:27], v[32:39], v28
    v_exp_f32 v43, v43
    v_exp_f32 v44, v44
    v_exp_f32 v45, v45
    v_exp_f32 v46, v46
    v_exp_f32 v47, v47
    v_exp_f32 v48, v48
    s_waitcnt lgkmcnt(0)
    v_exp_f32 v49, v49
    v_smfmac_f32_32x32x32_bf16 v[64:79], v[16:19], v[40:47], v28
    v_exp_f32 v50, v50
    v_exp_f32 v51, v51
    v_exp_f32 v52, v52
    v_mfma_f32_32x32x16_bf16 v[32:47], v[12:15], v[4:7], v[96:111]
    v_exp_f32 v53, v53
    v_exp_f32 v54, v54
    v_exp_f32 v55, v55
    v_exp_f32 v56, v56
    v_exp_f32 v57, v57
    v_exp_f32 v58, v58
    v_smfmac_f32_32x32x32_bf16 v[80:95], v[24:27], v[48:55], v28
    v_exp_f32 v59, v59
    v_exp_f32 v60, v60
    v_exp_f32 v61, v61
    v_exp_f32 v62, v62
    v_exp_f32 v63, v63
    v_exp_f32 v32, v32
    v_exp_f32 v33, v33
    v_smfmac_f32_32x32x32_bf16 v[80:95], v[16:19], v[56:63], v28
    s_mov_b64 exec, s[12:13]
    ds_read_b128 v[16:19], v30 offset:29184
    ds_read_b128 v[24:27], v30 offset:29696
    s_mov_b64 exec, -1
    v_exp_f32 v34, v34
    v_exp_f32 v35, v35
    v_exp_f32 v36, v36
    v_exp_f32 v37, v37
    v_mfma_f32_32x32x16_bf16 v[48:63], v[12:15], v[8:11], v[112:127]
    ds_read_b128 v[12:15], v29 offset:29696
    v_exp_f32 v38, v38
    v_exp_f32 v39, v39
    v_exp_f32 v40, v40
    v_exp_f32 v41, v41
    v_exp_f32 v42, v42
    v_smfmac_f32_32x32x32_bf16 v[64:79], v[20:23], v[32:39], v28
    v_exp_f32 v43, v43
    v_exp_f32 v44, v44
    v_exp_f32 v45, v45
    v_exp_f32 v46, v46
    v_exp_f32 v47, v47
    v_exp_f32 v48, v48
    s_waitcnt lgkmcnt(0)
    v_exp_f32 v49, v49
    v_smfmac_f32_32x32x32_bf16 v[64:79], v[16:19], v[40:47], v28
    v_exp_f32 v50, v50
    v_exp_f32 v51, v51
    v_exp_f32 v52, v52
    v_mfma_f32_32x32x16_bf16 v[32:47], v[12:15], v[4:7], v[96:111]
    v_exp_f32 v53, v53
    v_exp_f32 v54, v54
    v_exp_f32 v55, v55
    v_exp_f32 v56, v56
    v_exp_f32 v57, v57
    v_exp_f32 v58, v58
    v_smfmac_f32_32x32x32_bf16 v[80:95], v[20:23], v[48:55], v28
    v_exp_f32 v59, v59
    v_exp_f32 v60, v60
    v_exp_f32 v61, v61
    v_exp_f32 v62, v62
    v_exp_f32 v63, v63
    v_exp_f32 v32, v32
    v_exp_f32 v33, v33
    v_smfmac_f32_32x32x32_bf16 v[80:95], v[16:19], v[56:63], v28
    s_mov_b64 exec, s[12:13]
    ds_read_b128 v[16:19], v30 offset:30208
    ds_read_b128 v[20:23], v30 offset:30720
    s_mov_b64 exec, -1
    v_exp_f32 v34, v34
    v_exp_f32 v35, v35
    v_exp_f32 v36, v36
    v_exp_f32 v37, v37
    v_mfma_f32_32x32x16_bf16 v[48:63], v[12:15], v[8:11], v[112:127]
    ds_read_b128 v[12:15], v29 offset:30720
    v_exp_f32 v38, v38
    v_exp_f32 v39, v39
    v_exp_f32 v40, v40
    v_exp_f32 v41, v41
    v_exp_f32 v42, v42
    v_smfmac_f32_32x32x32_bf16 v[64:79], v[24:27], v[32:39], v28
    v_exp_f32 v43, v43
    v_exp_f32 v44, v44
    v_exp_f32 v45, v45
    v_exp_f32 v46, v46
    v_exp_f32 v47, v47
    v_exp_f32 v48, v48
    s_waitcnt lgkmcnt(0)
    v_exp_f32 v49, v49
    v_smfmac_f32_32x32x32_bf16 v[64:79], v[16:19], v[40:47], v28
    v_exp_f32 v50, v50
    v_exp_f32 v51, v51
    v_exp_f32 v52, v52
    v_mfma_f32_32x32x16_bf16 v[32:47], v[12:15], v[4:7], v[96:111]
    v_exp_f32 v53, v53
    v_exp_f32 v54, v54
    v_exp_f32 v55, v55
    v_exp_f32 v56, v56
    v_exp_f32 v57, v57
    v_exp_f32 v58, v58
    v_smfmac_f32_32x32x32_bf16 v[80:95], v[24:27], v[48:55], v28
    v_exp_f32 v59, v59
    v_exp_f32 v60, v60
    v_exp_f32 v61, v61
    v_exp_f32 v62, v62
    v_exp_f32 v63, v63
    v_exp_f32 v32, v32
    v_exp_f32 v33, v33
    v_smfmac_f32_32x32x32_bf16 v[80:95], v[16:19], v[56:63], v28
    s_mov_b64 exec, s[12:13]
    ds_read_b128 v[16:19], v30 offset:31232
    ds_read_b128 v[24:27], v30 offset:31744
    s_mov_b64 exec, -1
    v_exp_f32 v34, v34
    v_exp_f32 v35, v35
    v_exp_f32 v36, v36
    v_exp_f32 v37, v37
    v_mfma_f32_32x32x16_bf16 v[48:63], v[12:15], v[8:11], v[112:127]
    ds_read_b128 v[12:15], v29 offset:31744
    v_exp_f32 v38, v38
    v_exp_f32 v39, v39
    v_exp_f32 v40, v40
    v_exp_f32 v41, v41
    v_exp_f32 v42, v42
    v_smfmac_f32_32x32x32_bf16 v[64:79], v[20:23], v[32:39], v28
    v_exp_f32 v43, v43
    v_exp_f32 v44, v44
    v_exp_f32 v45, v45
    v_exp_f32 v46, v46
    v_exp_f32 v47, v47
    v_exp_f32 v48, v48
    s_waitcnt lgkmcnt(0)
    v_exp_f32 v49, v49
    v_smfmac_f32_32x32x32_bf16 v[64:79], v[16:19], v[40:47], v28
    v_exp_f32 v50, v50
    v_exp_f32 v51, v51
    v_exp_f32 v52, v52
    v_mfma_f32_32x32x16_bf16 v[32:47], v[12:15], v[4:7], v[96:111]
    v_exp_f32 v53, v53
    v_exp_f32 v54, v54
    v_exp_f32 v55, v55
    v_exp_f32 v56, v56
    v_exp_f32 v57, v57
    v_exp_f32 v58, v58
    v_smfmac_f32_32x32x32_bf16 v[80:95], v[20:23], v[48:55], v28
    v_exp_f32 v59, v59
    v_exp_f32 v60, v60
    v_exp_f32 v61, v61
    v_exp_f32 v62, v62
    v_exp_f32 v63, v63
    v_exp_f32 v32, v32
    v_exp_f32 v33, v33
    v_smfmac_f32_32x32x32_bf16 v[80:95], v[16:19], v[56:63], v28
    s_mov_b64 exec, s[12:13]
    ds_read_b128 v[16:19], v30 offset:32256
    s_mov_b64 exec, -1
    ds_read_b32 v134, v31 offset:120
    v_exp_f32 v34, v34
    v_exp_f32 v35, v35
    v_exp_f32 v36, v36
    v_mfma_f32_32x32x16_bf16 v[48:63], v[12:15], v[8:11], v[112:127]
    v_exp_f32 v37, v37
    v_exp_f32 v38, v38
    v_exp_f32 v39, v39
    v_exp_f32 v40, v40
    v_exp_f32 v41, v41
    v_exp_f32 v42, v42
    v_smfmac_f32_32x32x32_bf16 v[64:79], v[24:27], v[32:39], v28
    v_exp_f32 v43, v43
    v_exp_f32 v44, v44
    v_exp_f32 v45, v45
    v_exp_f32 v46, v46
    v_exp_f32 v47, v47
    v_exp_f32 v48, v48
    s_waitcnt lgkmcnt(0)
    v_exp_f32 v49, v49
    v_smfmac_f32_32x32x32_bf16 v[64:79], v[16:19], v[40:47], v28
    v_exp_f32 v50, v50
    v_exp_f32 v51, v51
    v_exp_f32 v52, v52
    v_exp_f32 v53, v53
    v_exp_f32 v54, v54
    v_exp_f32 v55, v55
    v_exp_f32 v56, v56
    v_exp_f32 v57, v57
    v_exp_f32 v58, v58
    v_smfmac_f32_32x32x32_bf16 v[80:95], v[24:27], v[48:55], v28
    v_exp_f32 v59, v59
    v_exp_f32 v60, v60
    v_exp_f32 v61, v61
    v_exp_f32 v62, v62
    v_exp_f32 v63, v63
    s_mul_i32 s54, s3, 3072
    s_add_u32 s54, s54, 0
    v_smfmac_f32_32x32x32_bf16 v[80:95], v[16:19], v[56:63], v28
    v_add_u32 v128, s54, v1
    s_xor_b32 s54, s3, 4
    s_mul_i32 s54, s54, 3072
    s_add_u32 s54, s54, 0
    v_add_u32 v129, s54, v1
    s_add_u32 s20, s20, s21
    s_lshl_b32 s54, s20, 5
    s_add_u32 s54, s54, s22
    s_mul_i32 s55, s20, 4352
    s_lshl_b32 s56, s22, 7
    s_add_u32 s55, s55, s56
    s_add_u32 s55, s55, 13840640
    s_lshl_b32 s54, s54, 10
    s_add_u32 s54, s54, 6553600
    s_setprio 0
    v_readfirstlane_b32 s64, v134
    s_nop 0
    s_cmp_lt_u32 s64, 4
    s_cbranch_scc1 AS_19
AB_20:
    v_mov_b32 v89, v112
    ds_write_b128 v128, v[80:83]
    ds_write_b128 v128, v[84:87] offset:1024
    ds_write_b128 v128, v[88:91] offset:2048
    s_branch L_ATT_X
GSL_5:
    s_mov_b32 s65, 1048576
MW_21:
    ds_read_b128 v[24:27], v20
    s_waitcnt lgkmcnt(0)
MWC_23:
    v_min3_u32 v24, v24, v25, v26
    v_min_u32 v24, v24, v27
    s_sub_u32 s65, s65, 1
    s_cbranch_scc1 MWD_22
    v_readfirstlane_b32 s64, v24
    s_nop 0
    s_cmp_ge_u32 s64, s58
    s_cbranch_scc1 MWD_22
    s_sleep 1
    s_branch MW_21
MWD_22:
    s_branch GB_4
GSL_8:
    s_mov_b32 s65, 1048576
MW_24:
    ds_read_b128 v[24:27], v20
    s_waitcnt lgkmcnt(0)
MWC_26:
    v_min3_u32 v24, v24, v25, v26
    v_min_u32 v24, v24, v27
    s_sub_u32 s65, s65, 1
    s_cbranch_scc1 MWD_25
    v_readfirstlane_b32 s64, v24
    s_nop 0
    s_cmp_ge_u32 s64, s58
    s_cbranch_scc1 MWD_25
    s_sleep 1
    s_branch MW_24
MWD_25:
    s_branch GB_7
GSL_11:
    s_mov_b32 s65, 1048576
MW_27:
    ds_read_b128 v[24:27], v20
    s_waitcnt lgkmcnt(0)
MWC_29:
    v_min3_u32 v24, v24, v25, v26
    v_min_u32 v24, v24, v27
    s_sub_u32 s65, s65, 1
    s_cbranch_scc1 MWD_28
    v_readfirstlane_b32 s64, v24
    s_nop 0
    s_cmp_ge_u32 s64, s58
    s_cbranch_scc1 MWD_28
    s_sleep 1
    s_branch MW_27
MWD_28:
    s_branch GB_10
GSL_14:
    s_mov_b32 s65, 1048576
MW_30:
    ds_read_b128 v[24:27], v20
    s_waitcnt lgkmcnt(0)
MWC_32:
    v_min3_u32 v24, v24, v25, v26
    v_min_u32 v24, v24, v27
    s_sub_u32 s65, s65, 1
    s_cbranch_scc1 MWD_31
    v_readfirstlane_b32 s64, v24
    s_nop 0
    s_cmp_ge_u32 s64, s58
    s_cbranch_scc1 MWD_31
    s_sleep 1
    s_branch MW_30
MWD_31:
    s_branch GB_13
L_GS_XT:
    ds_read_b64_tr_b16 v[160:161], v144 offset:0
    ds_read_b64_tr_b16 v[162:163], v145 offset:512
    ds_read_b64_tr_b16 v[164:165], v146 offset:1024
    ds_read_b64_tr_b16 v[166:167], v147 offset:1536
    s_waitcnt lgkmcnt(0)
    ds_write_b128 v29, v[160:163]
    ds_write_b128 v29, v[164:167] offset:1024
    ds_write_b32 v21, v21 offset:80
    s_branch L_GS_XTB
L_KGEN:
    s_setprio 2
    s_bfe_u32 s51, s3, 0x10001
    s_and_b32 s52, s3, 1
    s_and_b32 s53, s2, 7
    s_lshl_b32 s53, s53, 5
    s_lshr_b32 s57, s2, 3
    s_add_u32 s53, s53, s57
    s_lshl_b32 s59, s53, 2
    s_lshl_b32 s53, s53, 1
    s_add_u32 s53, s53, s51
    s_lshl_b32 s57, s53, 8
    s_lshl_b32 s58, s52, 7
    s_add_u32 s57, s57, s58
    v_lshl_add_u32 v6, v0, 1, s57
    s_waitcnt lgkmcnt(0)
    global_load_ushort v8, v6, s[12:13]
    global_load_ushort v9, v6, s[14:15]
    global_load_ushort v10, v6, s[16:17]
    global_load_ushort v11, v6, s[18:19]
    s_load_dword s62, s[20:21], s59
    s_load_dword s63, s[22:23], s59
    s_mov_b32 s40, s26
    s_and_b32 s41, s27, 0xffff
    s_mov_b32 s42, 0xe00000
    s_mov_b32 s43, 0x20000
    s_barrier
    s_setprio 2
    s_mul_i32 s54, s51, 16128
    s_add_u32 s54, s54, 0
    s_mul_i32 s55, s52, 8064
    s_add_u32 s55, s55, s54
    s_mul_i32 s56, s51, 2688
    s_add_u32 s56, s56, 155136
    s_mov_b32 s60, 0
    s_mov_b32 s61, -1
    v_mov_b32 v6, 0x43800000
    v_cndmask_b32 v16, 1.0, v6, s[60:61]
    v_mov_b32 v7, 0x44010000
    v_cndmask_b32 v18, v6, v7, s[60:61]
    v_cvt_f32_u32 v6, v3
    v_mul_f32 v17, 0x44000000, v6
    v_mul_f32 v19, 0x43000000, v6
    v_add_f32 v166, 0x42800000, v19
    v_lshl_add_u32 v6, v2, 2, s55
    v_mul_u32_u24 v7, 576, v3
    v_lshl_add_u32 v20, v7, 1, v6
    v_add_u32 v21, v7, v6
    v_add_u32 v21, 2304, v21
    v_lshl_add_u32 v162, v7, 2, v6
    v_add_u32 v163, 4608, v162
    v_add_u32 v162, 3456, v162
    v_mul_u32_u24 v6, 144, v2
    v_lshl_add_u32 v6, v3, 4, v6
    v_add_u32 v23, s55, v6
    v_lshlrev_b32 v6, 3, v2
    v_lshl_add_u32 v6, v3, 2, v6
    v_lshl_add_u32 v24, v6, 2, s56
    v_lshlrev_b32 v6, 1, v2
    v_add_u32 v7, 384, v6
    v_add_u32 v76, 576, v2
    v_cndmask_b32 v7, v7, v76, s[60:61]
    v_lshl_add_u32 v25, v7, 2, s56
    v_cndmask_b32 v7, 64, 32, s[60:61]
    v_lshl_add_u32 v26, v7, 2, v25
    v_lshl_add_u32 v7, v3, 7, v2
    v_add_u32 v7, 512, v7
    v_lshl_add_u32 v27, v7, 2, s56
    v_add_u32 v6, 385, v6
    v_lshlrev_b32 v7, 2, v2
    v_add_u32 v7, 256, v7
    v_cndmask_b32 v7, v7, v6, s[60:61]
    v_lshl_add_u32 v28, v7, 2, s56
    s_sub_u32 s57, s56, 68096
    s_lshl_b32 s58, s52, 10
    s_sub_u32 s58, 2047, s58
    v_lshlrev_b32 v6, 3, v0
    v_sub_u32 v76, s58, v6
    v_cvt_f32_u32 v77, v76
    v_add_f32 v78, 0xbf800000, v77
    v_add_f32 v79, 0xc0000000, v77
    v_add_f32 v80, 0xc0400000, v77
    v_add_f32 v81, 0xc0800000, v77
    v_add_f32 v82, 0xc0a00000, v77
    v_add_f32 v83, 0xc0c00000, v77
    v_add_f32 v84, 0xc0e00000, v77
    v_add_f32 v85, 0xc1000000, v77
    v_max_f32 v85, 0, v85
    v_cvt_pk_bf16_f32 v6, v77, v78
    v_and_b32 v7, 0xffff, v6
    v_lshl_add_u32 v144, v7, 2, s57
    v_lshrrev_b32 v6, 16, v6
    v_lshl_add_u32 v145, v6, 2, s57
    v_cvt_pk_bf16_f32 v6, v79, v80
    v_and_b32 v7, 0xffff, v6
    v_lshl_add_u32 v146, v7, 2, s57
    v_lshrrev_b32 v6, 16, v6
    v_lshl_add_u32 v147, v6, 2, s57
    v_cvt_pk_bf16_f32 v6, v81, v82
    v_and_b32 v7, 0xffff, v6
    v_lshl_add_u32 v148, v7, 2, s57
    v_lshrrev_b32 v6, 16, v6
    v_lshl_add_u32 v149, v6, 2, s57
    v_cvt_pk_bf16_f32 v6, v83, v84
    v_and_b32 v7, 0xffff, v6
    v_lshl_add_u32 v150, v7, 2, s57
    v_lshrrev_b32 v6, 16, v6
    v_lshl_add_u32 v151, v6, 2, s57
    v_cvt_pk_bf16_f32 v6, v85, v86
    v_and_b32 v7, 0xffff, v6
    v_lshl_add_u32 v152, v7, 2, s57
    s_lshl_b32 s58, s52, 10
    s_sub_u32 s58, 1535, s58
    v_lshlrev_b32 v6, 3, v0
    v_sub_u32 v76, s58, v6
    v_cvt_f32_u32 v77, v76
    v_add_f32 v78, 0xbf800000, v77
    v_add_f32 v79, 0xc0000000, v77
    v_add_f32 v80, 0xc0400000, v77
    v_add_f32 v81, 0xc0800000, v77
    v_add_f32 v82, 0xc0a00000, v77
    v_add_f32 v83, 0xc0c00000, v77
    v_add_f32 v84, 0xc0e00000, v77
    v_add_f32 v85, 0xc1000000, v77
    v_max_f32 v85, 0, v85
    v_cvt_pk_bf16_f32 v6, v77, v78
    v_and_b32 v7, 0xffff, v6
    v_lshl_add_u32 v153, v7, 2, s57
    v_lshrrev_b32 v6, 16, v6
    v_lshl_add_u32 v154, v6, 2, s57
    v_cvt_pk_bf16_f32 v6, v79, v80
    v_and_b32 v7, 0xffff, v6
    v_lshl_add_u32 v155, v7, 2, s57
    v_lshrrev_b32 v6, 16, v6
    v_lshl_add_u32 v156, v6, 2, s57
    v_cvt_pk_bf16_f32 v6, v81, v82
    v_and_b32 v7, 0xffff, v6
    v_lshl_add_u32 v157, v7, 2, s57
    v_lshrrev_b32 v6, 16, v6
    v_lshl_add_u32 v158, v6, 2, s57
    v_cvt_pk_bf16_f32 v6, v83, v84
    v_and_b32 v7, 0xffff, v6
    v_lshl_add_u32 v159, v7, 2, s57
    v_lshrrev_b32 v6, 16, v6
    v_lshl_add_u32 v160, v6, 2, s57
    v_cvt_pk_bf16_f32 v6, v85, v86
    v_and_b32 v7, 0xffff, v6
    v_lshl_add_u32 v161, v7, 2, s57
    v_subrev_u32 v6, 0, v76
    v_min_u32 v6, 0x80, v6
    v_lshl_add_u32 v6, v6, 2, s56
    v_max_i32 v153, v153, v6
    v_subrev_u32 v6, 1, v76
    v_min_u32 v6, 0x80, v6
    v_lshl_add_u32 v6, v6, 2, s56
    v_max_i32 v154, v154, v6
    v_subrev_u32 v6, 2, v76
    v_min_u32 v6, 0x80, v6
    v_lshl_add_u32 v6, v6, 2, s56
    v_max_i32 v155, v155, v6
    v_subrev_u32 v6, 3, v76
    v_min_u32 v6, 0x80, v6
    v_lshl_add_u32 v6, v6, 2, s56
    v_max_i32 v156, v156, v6
    v_subrev_u32 v6, 4, v76
    v_min_u32 v6, 0x80, v6
    v_lshl_add_u32 v6, v6, 2, s56
    v_max_i32 v157, v157, v6
    v_subrev_u32 v6, 5, v76
    v_min_u32 v6, 0x80, v6
    v_lshl_add_u32 v6, v6, 2, s56
    v_max_i32 v158, v158, v6
    v_subrev_u32 v6, 6, v76
    v_min_u32 v6, 0x80, v6
    v_lshl_add_u32 v6, v6, 2, s56
    v_max_i32 v159, v159, v6
    v_subrev_u32 v6, 7, v76
    v_min_u32 v6, 0x80, v6
    v_lshl_add_u32 v6, v6, 2, s56
    v_max_i32 v160, v160, v6
    v_subrev_u32 v6, 8, v76
    v_max_i32 v6, 0, v6
    v_min_u32 v6, 0x80, v6
    v_lshl_add_u32 v6, v6, 2, s56
    v_max_i32 v161, v161, v6
    v_and_b32 v7, 1, v4
    v_cmp_eq_u32 vcc, 0, v7
    v_mov_b32 v7, 4158
    v_lshlrev_b32 v6, 1, v4
    v_cndmask_b32 v7, 0, v7, vcc
    v_sub_u32 v7, v7, v6
    v_lshl_add_u32 v7, v3, 4, v7
    v_add_u32 v7, 3902, v7
    s_lshl_b32 s57, s52, 10
    s_sub_u32 s57, s54, s57
    v_add_u32 v129, s57, v7
    v_subrev_u32 v131, 2048, v129
    v_mul_u32_u24 v7, 96, v3
    v_add_u32 v7, v7, v2
    s_lshl_b32 s57, s52, 8
    s_sub_u32 s57, s54, s57
    s_add_u32 s57, s57, 8784
    v_lshl_add_u32 v130, v7, 4, s57
    v_mov_b32 v48, 0
    v_mov_b32 v49, 0
    v_mov_b32 v50, 0
    v_mov_b32 v51, 0
    v_mov_b32 v52, 0
    v_mov_b32 v53, 0
    v_mov_b32 v54, 0
    v_mov_b32 v55, 0
    v_mov_b32 v56, 0
    v_mov_b32 v57, 0
    v_mov_b32 v58, 0
    v_mov_b32 v59, 0
    v_mov_b32 v60, 0
    v_mov_b32 v61, 0
    v_mov_b32 v62, 0
    v_mov_b32 v63, 0
    s_waitcnt vmcnt(0) lgkmcnt(0)
    s_lshl_b32 s58, s51, 4
    s_lshr_b32 s62, s62, s58
    s_lshl_b32 s62, s62, 16
    s_lshr_b32 s63, s63, s58
    s_lshl_b32 s63, s63, 16
    s_mov_b32 s59, 0x3fb8aa3b
    v_mov_b32 v6, s62
    v_mul_f32 v6, s59, v6
    v_lshlrev_b32 v8, 16, v8
    v_mul_f32 v8, s59, v8
    v_exp_f32 v6, v6
    v_exp_f32 v8, v8
    v_lshlrev_b32 v9, 16, v9
    v_lshlrev_b32 v10, 16, v10
    v_cvt_pk_bf16_f32 v6, v6, v8
    v_and_b32 v8, 0xffff0000, v6
    v_lshlrev_b32 v6, 16, v6
    v_mul_f32 v8, v8, v6
    v_mul_f32 v8, 0xbfb8aa3b, v8
    v_mul_f32 v9, v9, v6
    v_mul_f32 v9, 0.15915494, v9
    v_add_f32 v6, v6, v6
    v_lshlrev_b32 v11, 16, v11
    v_mul_f32 v10, v10, v6
    v_mul_f32 v11, -v11, v6
    v_mov_b32 v12, v8
    v_mov_b32 v13, v9
    v_mov_b32 v14, v10
    v_mov_b32 v15, v11
    s_mov_b32 s59, 0x41000000
    v_permlane32_swap_b32 v8, v12
    v_permlane32_swap_b32 v9, v13
    v_permlane32_swap_b32 v10, v14
    v_permlane32_swap_b32 v11, v15
    s_mov_b32 s62, 2
L_KP:
    v_mul_f32 v76, v8, v16
    v_mul_f32 v77, v9, v16
    v_mul_f32 v78, v8, v17
    v_mul_f32 v79, v9, v17
    v_mul_f32 v80, v8, v18
    v_mul_f32 v81, v9, v18
    v_mul_f32 v82, v8, v19
    v_mul_f32 v83, v9, v19
    v_mul_f32 v84, s59, v8
    v_mul_f32 v85, s59, v9
    v_exp_f32 v76, v76
    v_fract_f32 v77, v77
    v_exp_f32 v78, v78
    v_fract_f32 v79, v79
    v_exp_f32 v80, v80
    v_fract_f32 v81, v81
    v_exp_f32 v82, v82
    v_fract_f32 v83, v83
    v_exp_f32 v84, v84
    v_fract_f32 v85, v85
    v_cos_f32 v64, v77
    v_sin_f32 v65, v77
    v_cos_f32 v68, v79
    v_sin_f32 v69, v79
    v_cos_f32 v70, v81
    v_sin_f32 v71, v81
    v_cos_f32 v72, v83
    v_sin_f32 v73, v83
    v_cos_f32 v74, v85
    v_sin_f32 v75, v85
    v_mul_f32 v64, v76, v64
    v_mul_f32 v65, -v76, v65
    v_mul_f32 v68, v78, v68
    v_mul_f32 v69, -v78, v69
    v_mul_f32 v70, v80, v70
    v_mul_f32 v71, -v80, v71
    v_mul_f32 v72, v82, v72
    v_mul_f32 v73, v82, v73
    v_mul_f32 v74, v84, v74
    v_mul_f32 v75, v84, v75
    v_pk_mul_f32 v[76:77], v[68:69], v[10:11] op_sel:[0,0] op_sel_hi:[0,1]
    v_pk_mul_f32 v[78:79], v[70:71], v[10:11] op_sel:[0,0] op_sel_hi:[0,1]
    v_pk_mul_f32 v[80:81], v[64:65], v[64:65] op_sel:[0,0] op_sel_hi:[0,1]
    v_pk_fma_f32 v[68:69], v[68:69], v[10:11], v[76:77] op_sel:[1,1,0] op_sel_hi:[1,0,1] neg_lo:[1,0,0]
    v_pk_fma_f32 v[70:71], v[70:71], v[10:11], v[78:79] op_sel:[1,1,0] op_sel_hi:[1,0,1] neg_lo:[1,0,0]
    v_pk_fma_f32 v[66:67], v[64:65], v[64:65], v[80:81] op_sel:[1,1,0] op_sel_hi:[1,0,1] neg_lo:[1,0,0]
    v_cndmask_b32 v66, v66, v64, s[60:61]
    v_cndmask_b32 v67, v67, v65, s[60:61]
    v_cvt_pk_bf16_f32 v86, v72, v73
    v_pk_mul_f32 v[76:77], v[72:73], v[74:75] op_sel:[0,0] op_sel_hi:[0,1]
    v_cvt_pk_bf16_f32 v90, v68, v69
    v_pk_mul_f32 v[78:79], v[68:69], v[64:65] op_sel:[0,0] op_sel_hi:[0,1]
    v_pk_fma_f32 v[72:73], v[72:73], v[74:75], v[76:77] op_sel:[1,1,0] op_sel_hi:[1,0,1] neg_lo:[1,0,0]
    v_pk_fma_f32 v[68:69], v[68:69], v[64:65], v[78:79] op_sel:[1,1,0] op_sel_hi:[1,0,1] neg_lo:[1,0,0]
    v_cvt_pk_bf16_f32 v87, v72, v73
    v_pk_mul_f32 v[76:77], v[72:73], v[74:75] op_sel:[0,0] op_sel_hi:[0,1]
    v_cvt_pk_bf16_f32 v91, v68, v69
    v_pk_mul_f32 v[78:79], v[68:69], v[64:65] op_sel:[0,0] op_sel_hi:[0,1]
    v_pk_fma_f32 v[72:73], v[72:73], v[74:75], v[76:77] op_sel:[1,1,0] op_sel_hi:[1,0,1] neg_lo:[1,0,0]
    ds_write2_b32 v162, v86, v87 offset0:0 offset1:36
    v_pk_fma_f32 v[68:69], v[68:69], v[64:65], v[78:79] op_sel:[1,1,0] op_sel_hi:[1,0,1] neg_lo:[1,0,0]
    ds_write2_b32 v20, v90, v91 offset0:0 offset1:36
    v_cvt_pk_bf16_f32 v88, v72, v73
    v_pk_mul_f32 v[76:77], v[72:73], v[74:75] op_sel:[0,0] op_sel_hi:[0,1]
    v_cvt_pk_bf16_f32 v92, v68, v69
    v_pk_mul_f32 v[78:79], v[68:69], v[64:65] op_sel:[0,0] op_sel_hi:[0,1]
    v_pk_fma_f32 v[72:73], v[72:73], v[74:75], v[76:77] op_sel:[1,1,0] op_sel_hi:[1,0,1] neg_lo:[1,0,0]
    v_pk_fma_f32 v[68:69], v[68:69], v[64:65], v[78:79] op_sel:[1,1,0] op_sel_hi:[1,0,1] neg_lo:[1,0,0]
    v_cvt_pk_bf16_f32 v89, v72, v73
    v_pk_mul_f32 v[76:77], v[72:73], v[74:75] op_sel:[0,0] op_sel_hi:[0,1]
    v_cvt_pk_bf16_f32 v93, v68, v69
    v_pk_mul_f32 v[78:79], v[68:69], v[64:65] op_sel:[0,0] op_sel_hi:[0,1]
    v_pk_fma_f32 v[72:73], v[72:73], v[74:75], v[76:77] op_sel:[1,1,0] op_sel_hi:[1,0,1] neg_lo:[1,0,0]
    ds_write2_b32 v162, v88, v89 offset0:72 offset1:108
    v_pk_fma_f32 v[68:69], v[68:69], v[64:65], v[78:79] op_sel:[1,1,0] op_sel_hi:[1,0,1] neg_lo:[1,0,0]
    ds_write2_b32 v20, v92, v93 offset0:72 offset1:108
    v_cvt_pk_bf16_f32 v86, v72, v73
    v_pk_mul_f32 v[76:77], v[72:73], v[74:75] op_sel:[0,0] op_sel_hi:[0,1]
    v_cvt_pk_bf16_f32 v90, v68, v69
    v_pk_mul_f32 v[78:79], v[68:69], v[64:65] op_sel:[0,0] op_sel_hi:[0,1]
    v_pk_fma_f32 v[72:73], v[72:73], v[74:75], v[76:77] op_sel:[1,1,0] op_sel_hi:[1,0,1] neg_lo:[1,0,0]
    v_pk_fma_f32 v[68:69], v[68:69], v[64:65], v[78:79] op_sel:[1,1,0] op_sel_hi:[1,0,1] neg_lo:[1,0,0]
    v_cvt_pk_bf16_f32 v87, v72, v73
    v_pk_mul_f32 v[76:77], v[72:73], v[74:75] op_sel:[0,0] op_sel_hi:[0,1]
    v_cvt_pk_bf16_f32 v91, v68, v69
    v_pk_mul_f32 v[78:79], v[68:69], v[64:65] op_sel:[0,0] op_sel_hi:[0,1]
    v_pk_fma_f32 v[72:73], v[72:73], v[74:75], v[76:77] op_sel:[1,1,0] op_sel_hi:[1,0,1] neg_lo:[1,0,0]
    ds_write2_b32 v162, v86, v87 offset0:144 offset1:180
    v_pk_fma_f32 v[68:69], v[68:69], v[64:65], v[78:79] op_sel:[1,1,0] op_sel_hi:[1,0,1] neg_lo:[1,0,0]
    ds_write2_b32 v20, v90, v91 offset0:144 offset1:180
    v_cvt_pk_bf16_f32 v88, v72, v73
    v_pk_mul_f32 v[76:77], v[72:73], v[74:75] op_sel:[0,0] op_sel_hi:[0,1]
    v_cvt_pk_bf16_f32 v92, v68, v69
    v_pk_mul_f32 v[78:79], v[68:69], v[64:65] op_sel:[0,0] op_sel_hi:[0,1]
    v_pk_fma_f32 v[72:73], v[72:73], v[74:75], v[76:77] op_sel:[1,1,0] op_sel_hi:[1,0,1] neg_lo:[1,0,0]
    v_pk_fma_f32 v[68:69], v[68:69], v[64:65], v[78:79] op_sel:[1,1,0] op_sel_hi:[1,0,1] neg_lo:[1,0,0]
    v_cvt_pk_bf16_f32 v89, v72, v73
    v_pk_mul_f32 v[76:77], v[72:73], v[74:75] op_sel:[0,0] op_sel_hi:[0,1]
    v_cvt_pk_bf16_f32 v93, v68, v69
    v_pk_fma_f32 v[72:73], v[72:73], v[74:75], v[76:77] op_sel:[1,1,0] op_sel_hi:[1,0,1] neg_lo:[1,0,0]
    ds_write2_b32 v162, v88, v89 offset0:216 offset1:252
    ds_write2_b32 v20, v92, v93 offset0:216 offset1:252
    v_cvt_pk_bf16_f32 v86, v72, v73
    v_pk_mul_f32 v[76:77], v[72:73], v[74:75] op_sel:[0,0] op_sel_hi:[0,1]
    v_cvt_pk_bf16_f32 v90, v70, v71
    v_pk_mul_f32 v[78:79], v[70:71], v[66:67] op_sel:[0,0] op_sel_hi:[0,1]
    v_pk_fma_f32 v[72:73], v[72:73], v[74:75], v[76:77] op_sel:[1,1,0] op_sel_hi:[1,0,1] neg_lo:[1,0,0]
    v_pk_fma_f32 v[70:71], v[70:71], v[66:67], v[78:79] op_sel:[1,1,0] op_sel_hi:[1,0,1] neg_lo:[1,0,0]
    v_cvt_pk_bf16_f32 v87, v72, v73
    v_pk_mul_f32 v[76:77], v[72:73], v[74:75] op_sel:[0,0] op_sel_hi:[0,1]
    v_cvt_pk_bf16_f32 v91, v70, v71
    v_pk_mul_f32 v[78:79], v[70:71], v[66:67] op_sel:[0,0] op_sel_hi:[0,1]
    v_pk_fma_f32 v[72:73], v[72:73], v[74:75], v[76:77] op_sel:[1,1,0] op_sel_hi:[1,0,1] neg_lo:[1,0,0]
    ds_write2_b32 v163, v86, v87 offset0:0 offset1:36
    v_pk_fma_f32 v[70:71], v[70:71], v[66:67], v[78:79] op_sel:[1,1,0] op_sel_hi:[1,0,1] neg_lo:[1,0,0]
    ds_write2_b32 v21, v90, v91 offset0:0 offset1:36
    v_cvt_pk_bf16_f32 v88, v72, v73
    v_pk_mul_f32 v[76:77], v[72:73], v[74:75] op_sel:[0,0] op_sel_hi:[0,1]
    v_cvt_pk_bf16_f32 v92, v70, v71
    v_pk_mul_f32 v[78:79], v[70:71], v[66:67] op_sel:[0,0] op_sel_hi:[0,1]
    v_pk_fma_f32 v[72:73], v[72:73], v[74:75], v[76:77] op_sel:[1,1,0] op_sel_hi:[1,0,1] neg_lo:[1,0,0]
    v_pk_fma_f32 v[70:71], v[70:71], v[66:67], v[78:79] op_sel:[1,1,0] op_sel_hi:[1,0,1] neg_lo:[1,0,0]
    v_cvt_pk_bf16_f32 v89, v72, v73
    v_pk_mul_f32 v[76:77], v[72:73], v[74:75] op_sel:[0,0] op_sel_hi:[0,1]
    v_cvt_pk_bf16_f32 v93, v70, v71
    v_pk_fma_f32 v[72:73], v[72:73], v[74:75], v[76:77] op_sel:[1,1,0] op_sel_hi:[1,0,1] neg_lo:[1,0,0]
    ds_write2_b32 v163, v88, v89 offset0:72 offset1:108
    ds_write2_b32 v21, v92, v93 offset0:72 offset1:108
    v_cvt_pk_bf16_f32 v86, v72, v73
    v_pk_mul_f32 v[76:77], v[72:73], v[74:75] op_sel:[0,0] op_sel_hi:[0,1]
    v_pk_fma_f32 v[72:73], v[72:73], v[74:75], v[76:77] op_sel:[1,1,0] op_sel_hi:[1,0,1] neg_lo:[1,0,0]
    v_cvt_pk_bf16_f32 v87, v72, v73
    v_pk_mul_f32 v[76:77], v[72:73], v[74:75] op_sel:[0,0] op_sel_hi:[0,1]
    v_pk_fma_f32 v[72:73], v[72:73], v[74:75], v[76:77] op_sel:[1,1,0] op_sel_hi:[1,0,1] neg_lo:[1,0,0]
    ds_write2_b32 v163, v86, v87 offset0:144 offset1:180
    v_cvt_pk_bf16_f32 v88, v72, v73
    v_pk_mul_f32 v[76:77], v[72:73], v[74:75] op_sel:[0,0] op_sel_hi:[0,1]
    v_pk_fma_f32 v[72:73], v[72:73], v[74:75], v[76:77] op_sel:[1,1,0] op_sel_hi:[1,0,1] neg_lo:[1,0,0]
    v_cvt_pk_bf16_f32 v89, v72, v73
    ds_write2_b32 v163, v88, v89 offset0:216 offset1:252
    s_waitcnt lgkmcnt(0)
    ds_read_b128 v[96:99], v23 offset:0
    ds_read_b128 v[112:115], v23 offset:3456
    ds_read_b128 v[100:103], v23 offset:32
    ds_read_b128 v[116:119], v23 offset:3488
    ds_read_b128 v[104:107], v23 offset:64
    ds_read_b128 v[120:123], v23 offset:3520
    ds_read_b128 v[108:111], v23 offset:96
    ds_read_b128 v[124:127], v23 offset:3552
    v_mov_b32 v8, v12
    v_mov_b32 v9, v13
    v_mov_b32 v10, v14
    v_mov_b32 v11, v15
    s_sub_u32 s62, s62, 1
    s_cmp_lg_u32 s62, 0
    s_waitcnt lgkmcnt(6)
    v_mfma_f32_32x32x16_bf16 v[48:63], v[96:99], v[112:115], v[48:63]
    s_waitcnt lgkmcnt(4)
    v_mfma_f32_32x32x16_bf16 v[48:63], v[100:103], v[116:119], v[48:63]
    s_waitcnt lgkmcnt(2)
    v_mfma_f32_32x32x16_bf16 v[48:63], v[104:107], v[120:123], v[48:63]
    s_waitcnt lgkmcnt(0)
    v_mfma_f32_32x32x16_bf16 v[48:63], v[108:111], v[124:127], v[48:63]
    s_cbranch_scc1 L_KP
    s_setprio 0
    s_lshl_b32 s57, s51, 2
    v_mov_b32 v134, 163368
    v_add_u32 v134, s57, v134
    s_add_u32 s57, s54, 8064
    v_add_u32 v23, s57, v1
    s_cmp_eq_u32 s52, 0
    s_cbranch_scc1 L_KSUM
    s_nop 2
    ds_write_b128 v23, v[48:51] offset:0
    ds_write_b128 v23, v[52:55] offset:1024
    ds_write_b128 v23, v[56:59] offset:2048
    v_mov_b32 v7, 1
    s_waitcnt lgkmcnt(0)
    s_mov_b64 exec, 1
    ds_add_u32 v134, v7
    s_mov_b64 exec, -1
    s_setprio 0
    s_branch L_KSIG
L_KSUM:
    s_mov_b32 s65, 1048576
LW_33:
    ds_read_b32 v6, v134
    s_waitcnt lgkmcnt(0)
    v_readfirstlane_b32 s64, v6
    s_sub_u32 s65, s65, 1
    s_cbranch_scc1 LWD_34
    s_cmp_lt_u32 s64, 1
    s_cbranch_scc0 LWD_34
    s_sleep 1
    s_branch LW_33
LWD_34:
    ds_read_b128 v[96:99], v23 offset:0
    ds_read_b128 v[100:103], v23 offset:1024
    ds_read_b128 v[104:107], v23 offset:2048
    s_waitcnt lgkmcnt(0)
    v_mov_b32 v6, 163400
    v_mov_b32 v7, 1
    s_mov_b64 exec, 1
    ds_add_u32 v6, v7
    s_mov_b64 exec, -1
    v_add_f32 v48, v48, v96
    v_add_f32 v49, v49, v97
    v_add_f32 v50, v50, v98
    v_add_f32 v51, v51, v99
    v_add_f32 v52, v52, v100
    v_add_f32 v53, v53, v101
    v_add_f32 v54, v54, v102
    v_add_f32 v55, v55, v103
    v_add_f32 v56, v56, v104
    v_add_f32 v57, v57, v105
    v_add_f32 v58, v58, v106
    v_add_f32 v59, v59, v107
    ds_write_b128 v24, v[48:51]
    ds_write_b32 v25, v52
    ds_write_b32 v26, v53
    ds_write_b32 v27, v54
    s_mov_b32 exec_hi, 0
    ds_write_b32 v27, v55 offset:128
    ds_write_b128 v28, v[56:59]
    s_not_b64 exec, exec
    ds_write2st64_b32 v28, v56, v57 offset0:0 offset1:1
    s_mov_b64 exec, -1
    v_mov_b32 v7, 1
    s_waitcnt lgkmcnt(0)
    s_mov_b64 exec, 1
    ds_add_u32 v134, v7
    s_mov_b64 exec, -1
L_KSIG:
    v_mov_b32 v6, 163360
    s_mov_b32 s65, 1048576
LW_35:
    ds_read_b32 v7, v6
    s_waitcnt lgkmcnt(0)
    v_readfirstlane_b32 s50, v7
    s_sub_u32 s65, s65, 1
    s_cbranch_scc1 LWD_36
    s_cmp_eq_u32 s50, 0
    s_cbranch_scc0 LWD_36
    s_sleep 1
    s_branch LW_35
LWD_36:
    s_mov_b32 s65, 1048576
LW_37:
    ds_read_b32 v6, v134
    s_waitcnt lgkmcnt(0)
    v_readfirstlane_b32 s64, v6
    s_sub_u32 s65, s65, 1
    s_cbranch_scc1 LWD_38
    s_cmp_lt_u32 s64, 2
    s_cbranch_scc0 LWD_38
    s_sleep 1
    s_branch LW_37
LWD_38:
    s_setprio 0
    s_and_b32 s22, s2, 31
    s_lshr_b32 s20, s2, 5
    s_lshl_b32 s20, s20, 2
    s_and_b32 s23, s3, 3
    s_add_u32 s20, s20, s23
    s_lshl_b32 s20, s20, 1
    s_lshr_b32 s21, s3, 2
    s_lshl_b32 s24, s21, 15
    s_lshl_b32 s23, s23, 11
    s_add_u32 s23, s23, 155136
    v_mov_b32 v28, 0xdddd
    v_add_u32 v29, s24, v1
    v_add_u32 v29, 32256, v29
    v_and_b32 v128, 15, v2
    v_lshlrev_b32 v128, 4, v128
    v_lshl_add_u32 v128, v3, 8, v128
    s_add_u32 s24, s24, 97792
    v_add_u32 v30, s24, v128
    v_cmp_eq_u32 vcc, 16, v2
    v_mov_b32 v128, 0x3f803f80
    s_mov_b32 s12, 0xffff
    s_mov_b32 s13, 0xffff
    v_cndmask_b32 v16, 0, v128, vcc
    v_add_u32 v128, s23, v1
    v_mov_b32 v17, v16
    v_mov_b32 v18, v16
    v_mov_b32 v19, v16
    v_mov_b32 v20, v16
    v_mov_b32 v21, v16
    v_mov_b32 v22, v16
    v_mov_b32 v23, v16
    v_mov_b32 v24, v16
    v_mov_b32 v25, v16
    v_mov_b32 v26, v16
    v_mov_b32 v27, v16
    v_mov_b32 v64, 0
    v_mov_b32 v65, 0
    v_mov_b32 v66, 0
    v_mov_b32 v67, 0
    v_mov_b32 v68, 0
    v_mov_b32 v69, 0
    v_mov_b32 v70, 0
    v_mov_b32 v71, 0
    v_mov_b32 v72, 0
    v_mov_b32 v73, 0
    v_mov_b32 v74, 0
    v_mov_b32 v75, 0
    v_mov_b32 v76, 0
    v_mov_b32 v77, 0
    v_mov_b32 v78, 0
    v_mov_b32 v79, 0
    v_mov_b32 v80, 0
    v_mov_b32 v81, 0
    v_mov_b32 v82, 0
    v_mov_b32 v83, 0
    v_mov_b32 v84, 0
    v_mov_b32 v85, 0
    v_mov_b32 v86, 0
    v_mov_b32 v87, 0
    v_mov_b32 v88, 0
    v_mov_b32 v89, 0
    v_mov_b32 v90, 0
    v_mov_b32 v91, 0
    v_mov_b32 v92, 0
    v_mov_b32 v93, 0
    v_mov_b32 v94, 0
    v_mov_b32 v95, 0
    v_mov_b32 v133, 163344
    s_mov_b32 s65, 1048576
MW_39:
    ds_read_b128 v[136:139], v133
    s_waitcnt lgkmcnt(0)
MWC_41:
    v_min3_u32 v136, v136, v137, v138
    v_min_u32 v136, v136, v139
    s_sub_u32 s65, s65, 1
    s_cbranch_scc1 MWD_40
    v_readfirstlane_b32 s64, v136
    s_nop 0
    s_cmp_ge_u32 s64, 5
    s_cbranch_scc1 MWD_40
    s_sleep 2
    s_branch MW_39
MWD_40:
    s_setprio 0
    ds_read_b32 v96, v144
    ds_read_b32 v97, v145
    ds_read_b32 v98, v146
    ds_read_b32 v99, v147
    ds_read_b32 v100, v148
    ds_read_b32 v101, v149
    ds_read_b32 v102, v150
    ds_read_b32 v103, v151
    ds_read_b32 v104, v152
    s_waitcnt lgkmcnt(4)
    ds_read_b32 v105, v153
    ds_read_b32 v106, v154
    ds_read_b32 v107, v155
    ds_read_b32 v108, v156
    ds_read_b32 v109, v157
    ds_read_b32 v110, v158
    ds_read_b32 v111, v159
    ds_read_b32 v112, v160
    ds_read_b32 v113, v161
    v_lshl_add_u32 v7, v0, 1, s52
    v_cmp_eq_u32 vcc, 0x7f, v7
    v_mov_b32 v6, s63
    s_lshl_b32 s57, s52, 11
    s_add_u32 s57, s57, s54
    v_cndmask_b32 v6, 0, v6, vcc
    v_add_u32 v135, s57, v1
    s_waitcnt lgkmcnt(0)
    v_add_f32 v112, v112, v6
    v_cndmask_b32 v113, v113, 0, vcc
    v_mov_b32 v6, 163364
    v_mov_b32 v7, 1
    s_mov_b64 exec, 1
    ds_add_u32 v6, v7
    s_mov_b64 exec, -1
    v_cvt_pk_bf16_f32 v32, v96, v97
    v_cvt_pk_bf16_f32 v33, v98, v99
    v_cvt_pk_bf16_f32 v34, v100, v101
    v_cvt_pk_bf16_f32 v35, v102, v103
    ds_write_b128 v135, v[32:35] offset:0
    v_cvt_pk_bf16_f32 v36, v97, v98
    v_cvt_pk_bf16_f32 v37, v99, v100
    v_cvt_pk_bf16_f32 v38, v101, v102
    v_cvt_pk_bf16_f32 v39, v103, v104
    ds_write_b128 v135, v[36:39] offset:4160
    v_cvt_pk_bf16_f32 v40, v105, v106
    v_cvt_pk_bf16_f32 v41, v107, v108
    v_cvt_pk_bf16_f32 v42, v109, v110
    v_cvt_pk_bf16_f32 v43, v111, v112
    ds_write_b128 v135, v[40:43] offset:1024
    v_cvt_pk_bf16_f32 v44, v106, v107
    v_cvt_pk_bf16_f32 v45, v108, v109
    v_cvt_pk_bf16_f32 v46, v110, v111
    v_cvt_pk_bf16_f32 v47, v112, v113
    ds_write_b128 v135, v[44:47] offset:5184
    v_mov_b32 v48, 0
    v_mov_b32 v49, 0
    v_mov_b32 v50, 0
    v_mov_b32 v51, 0
    v_mov_b32 v52, 0
    v_mov_b32 v53, 0
    v_mov_b32 v54, 0
    v_mov_b32 v55, 0
    v_mov_b32 v56, 0
    v_mov_b32 v57, 0
    v_mov_b32 v58, 0
    v_mov_b32 v59, 0
    v_mov_b32 v60, 0
    v_mov_b32 v61, 0
    v_mov_b32 v62, 0
    v_mov_b32 v63, 0
    v_bfe_u32 v6, v0, 2, 1
    v_mul_u32_u24 v6, 4096, v6
    v_add_u32 v6, v6, v1
    v_add_u32 v6, s54, v6
    s_mov_b64 exec, 0xff
    ds_write_b128 v6, v[48:51] offset:4096
    s_mov_b64 exec, -1
    v_mul_u32_u24 v6, 96, v3
    v_add_u32 v6, v6, v2
    s_mul_i32 s58, s52, 3072
    s_add_u32 s58, s58, s54
    v_lshl_add_u32 v6, v6, 4, s58
    ds_write_b128 v6, v[48:51] offset:8320
    v_pk_mov_b32 v[136:137], v[64:65], v[64:65] op_sel:[0,1]
    v_pk_mov_b32 v[138:139], v[64:65], v[64:65] op_sel:[0,1]
    v_pk_mov_b32 v[140:141], v[64:65], v[64:65] op_sel:[0,1]
    v_pk_mov_b32 v[142:143], v[64:65], v[64:65] op_sel:[0,1]
    v_pk_mov_b32 v[144:145], v[64:65], v[64:65] op_sel:[0,1]
    v_pk_mov_b32 v[146:147], v[64:65], v[64:65] op_sel:[0,1]
    v_pk_mov_b32 v[148:149], v[64:65], v[64:65] op_sel:[0,1]
    v_pk_mov_b32 v[150:151], v[64:65], v[64:65] op_sel:[0,1]
    v_pk_mov_b32 v[152:153], v[64:65], v[64:65] op_sel:[0,1]
    v_pk_mov_b32 v[154:155], v[64:65], v[64:65] op_sel:[0,1]
    v_pk_mov_b32 v[156:157], v[64:65], v[64:65] op_sel:[0,1]
    v_pk_mov_b32 v[158:159], v[64:65], v[64:65] op_sel:[0,1]
    v_pk_mov_b32 v[160:161], v[64:65], v[64:65] op_sel:[0,1]
    v_pk_mov_b32 v[162:163], v[64:65], v[64:65] op_sel:[0,1]
    v_pk_mov_b32 v[164:165], v[64:65], v[64:65] op_sel:[0,1]
    v_pk_mov_b32 v[166:167], v[64:65], v[64:65] op_sel:[0,1]
    v_mov_b32 v134, 163404
    v_mov_b32 v7, 1
    s_waitcnt lgkmcnt(0)
    s_mov_b64 exec, 1
    ds_add_u32 v134, v7
    s_mov_b64 exec, -1
    s_mov_b32 s65, 1048576
LW_42:
    ds_read_b32 v6, v134
    s_waitcnt lgkmcnt(0)
    v_readfirstlane_b32 s64, v6
    s_sub_u32 s65, s65, 1
    s_cbranch_scc1 LWD_43
    s_cmp_lt_u32 s64, 8
    s_cbranch_scc0 LWD_43
    s_sleep 1
    s_branch LW_42
LWD_43:
    v_mov_b32 v6, 163364
    s_mov_b32 s65, 1048576
LW_44:
    ds_read_b32 v7, v6
    s_waitcnt lgkmcnt(0)
    v_readfirstlane_b32 s64, v7
    s_sub_u32 s65, s65, 1
    s_cbranch_scc1 LWD_45
    s_cmp_lt_u32 s64, 8
    s_cbranch_scc0 LWD_45
    s_sleep 1
    s_branch LW_44
LWD_45:
    s_mov_b32 s59, 4
    s_setprio 0
    s_cmp_eq_u32 s52, 0
    s_cbranch_scc1 L_CV0
    ds_read2_b32 v[32:33], v129 offset0:56 offset1:57
    ds_read2_b32 v[34:35], v129 offset0:58 offset1:59
    ds_read_b128 v[36:39], v130 offset:3120
    ds_read_b128 v[40:43], v130 offset:3632
    ds_read2_b32 v[44:45], v131 offset0:56 offset1:57
    ds_read2_b32 v[46:47], v131 offset0:58 offset1:59
    ds_read2_b32 v[48:49], v129 offset0:48 offset1:49
    ds_read2_b32 v[50:51], v129 offset0:50 offset1:51
    ds_read_b128 v[52:55], v130 offset:48
    ds_read_b128 v[56:59], v130 offset:560
    ds_read2_b32 v[60:61], v131 offset0:48 offset1:49
    ds_read2_b32 v[62:63], v131 offset0:50 offset1:51
L_CL1:
    s_waitcnt lgkmcnt(6)
    v_mfma_f32_32x32x16_bf16 v[152:167], v[32:35], v[36:39], v[152:167]
    ds_read2_b32 v[96:97], v129 offset0:40 offset1:41
    ds_read2_b32 v[98:99], v129 offset0:42 offset1:43
    v_mfma_f32_32x32x16_bf16 v[136:151], v[32:35], v[40:43], v[136:151]
    ds_read_b128 v[100:103], v130 offset:3104
    ds_read_b128 v[104:107], v130 offset:3616
    v_mfma_f32_32x32x16_bf16 v[136:151], v[44:47], v[36:39], v[136:151]
    ds_read2_b32 v[108:109], v131 offset0:40 offset1:41
    ds_read2_b32 v[110:111], v131 offset0:42 offset1:43
    s_waitcnt lgkmcnt(6)
    v_mfma_f32_32x32x16_bf16 v[152:167], v[48:51], v[52:55], v[152:167]
    ds_read2_b32 v[112:113], v129 offset0:32 offset1:33
    ds_read2_b32 v[114:115], v129 offset0:34 offset1:35
    v_mfma_f32_32x32x16_bf16 v[136:151], v[48:51], v[56:59], v[136:151]
    ds_read_b128 v[116:119], v130 offset:32
    ds_read_b128 v[120:123], v130 offset:544
    v_mfma_f32_32x32x16_bf16 v[136:151], v[60:63], v[52:55], v[136:151]
    ds_read2_b32 v[124:125], v131 offset0:32 offset1:33
    ds_read2_b32 v[126:127], v131 offset0:34 offset1:35
    s_waitcnt lgkmcnt(6)
    v_mfma_f32_32x32x16_bf16 v[152:167], v[96:99], v[100:103], v[152:167]
    ds_read2_b32 v[32:33], v129 offset0:24 offset1:25
    ds_read2_b32 v[34:35], v129 offset0:26 offset1:27
    v_mfma_f32_32x32x16_bf16 v[136:151], v[96:99], v[104:107], v[136:151]
    ds_read_b128 v[36:39], v130 offset:3088
    ds_read_b128 v[40:43], v130 offset:3600
    v_mfma_f32_32x32x16_bf16 v[136:151], v[108:111], v[100:103], v[136:151]
    ds_read2_b32 v[44:45], v131 offset0:24 offset1:25
    ds_read2_b32 v[46:47], v131 offset0:26 offset1:27
    s_waitcnt lgkmcnt(6)
    v_mfma_f32_32x32x16_bf16 v[152:167], v[112:115], v[116:119], v[152:167]
    ds_read2_b32 v[48:49], v129 offset0:16 offset1:17
    ds_read2_b32 v[50:51], v129 offset0:18 offset1:19
    v_mfma_f32_32x32x16_bf16 v[136:151], v[112:115], v[120:123], v[136:151]
    ds_read_b128 v[52:55], v130 offset:16
    ds_read_b128 v[56:59], v130 offset:528
    v_mfma_f32_32x32x16_bf16 v[136:151], v[124:127], v[116:119], v[136:151]
    ds_read2_b32 v[60:61], v131 offset0:16 offset1:17
    ds_read2_b32 v[62:63], v131 offset0:18 offset1:19
    s_waitcnt lgkmcnt(6)
    v_mfma_f32_32x32x16_bf16 v[152:167], v[32:35], v[36:39], v[152:167]
    ds_read2_b32 v[96:97], v129 offset0:8 offset1:9
    ds_read2_b32 v[98:99], v129 offset0:10 offset1:11
    v_mfma_f32_32x32x16_bf16 v[136:151], v[32:35], v[40:43], v[136:151]
    ds_read_b128 v[100:103], v130 offset:3072
    ds_read_b128 v[104:107], v130 offset:3584
    v_mfma_f32_32x32x16_bf16 v[136:151], v[44:47], v[36:39], v[136:151]
    ds_read2_b32 v[108:109], v131 offset0:8 offset1:9
    ds_read2_b32 v[110:111], v131 offset0:10 offset1:11
    s_waitcnt lgkmcnt(6)
    v_mfma_f32_32x32x16_bf16 v[152:167], v[48:51], v[52:55], v[152:167]
    ds_read2_b32 v[112:113], v129 offset0:0 offset1:1
    ds_read2_b32 v[114:115], v129 offset0:2 offset1:3
    v_subrev_u32 v129, 256, v129
    v_mfma_f32_32x32x16_bf16 v[136:151], v[48:51], v[56:59], v[136:151]
    ds_read_b128 v[116:119], v130 offset:0
    ds_read_b128 v[120:123], v130 offset:512
    v_subrev_u32 v130, 64, v130
    v_mfma_f32_32x32x16_bf16 v[136:151], v[60:63], v[52:55], v[136:151]
    ds_read2_b32 v[124:125], v131 offset0:0 offset1:1
    ds_read2_b32 v[126:127], v131 offset0:2 offset1:3
    v_subrev_u32 v131, 256, v131
    s_sub_u32 s59, s59, 1
    s_cmp_lg_u32 s59, 0
    s_waitcnt lgkmcnt(6)
    v_mfma_f32_32x32x16_bf16 v[152:167], v[96:99], v[100:103], v[152:167]
    ds_read2_b32 v[32:33], v129 offset0:56 offset1:57
    ds_read2_b32 v[34:35], v129 offset0:58 offset1:59
    v_mfma_f32_32x32x16_bf16 v[136:151], v[96:99], v[104:107], v[136:151]
    ds_read_b128 v[36:39], v130 offset:3120
    ds_read_b128 v[40:43], v130 offset:3632
    v_mfma_f32_32x32x16_bf16 v[136:151], v[108:111], v[100:103], v[136:151]
    ds_read2_b32 v[44:45], v131 offset0:56 offset1:57
    ds_read2_b32 v[46:47], v131 offset0:58 offset1:59
    s_waitcnt lgkmcnt(6)
    v_mfma_f32_32x32x16_bf16 v[152:167], v[112:115], v[116:119], v[152:167]
    ds_read2_b32 v[48:49], v129 offset0:48 offset1:49
    ds_read2_b32 v[50:51], v129 offset0:50 offset1:51
    v_mfma_f32_32x32x16_bf16 v[136:151], v[112:115], v[120:123], v[136:151]
    ds_read_b128 v[52:55], v130 offset:48
    ds_read_b128 v[56:59], v130 offset:560
    v_mfma_f32_32x32x16_bf16 v[136:151], v[124:127], v[116:119], v[136:151]
    ds_read2_b32 v[60:61], v131 offset0:48 offset1:49
    ds_read2_b32 v[62:63], v131 offset0:50 offset1:51
    s_cbranch_scc1 L_CL1
    s_branch L_CV1
L_CV0:
    ds_read2_b32 v[32:33], v129 offset0:56 offset1:57
    ds_read2_b32 v[34:35], v129 offset0:58 offset1:59
    ds_read_b128 v[36:39], v130 offset:3120
    ds_read_b128 v[40:43], v130 offset:3632
    ds_read2_b32 v[44:45], v131 offset0:56 offset1:57
    ds_read2_b32 v[46:47], v131 offset0:58 offset1:59
    ds_read2_b32 v[48:49], v129 offset0:48 offset1:49
    ds_read2_b32 v[50:51], v129 offset0:50 offset1:51
    ds_read_b128 v[52:55], v130 offset:48
    ds_read_b128 v[56:59], v130 offset:560
    ds_read2_b32 v[60:61], v131 offset0:48 offset1:49
    ds_read2_b32 v[62:63], v131 offset0:50 offset1:51
L_CL0:
    s_waitcnt lgkmcnt(6)
    v_mfma_f32_32x32x16_bf16 v[136:151], v[32:35], v[36:39], v[136:151]
    ds_read2_b32 v[96:97], v129 offset0:40 offset1:41
    ds_read2_b32 v[98:99], v129 offset0:42 offset1:43
    v_mfma_f32_32x32x16_bf16 v[152:167], v[32:35], v[40:43], v[152:167]
    ds_read_b128 v[100:103], v130 offset:3104
    ds_read_b128 v[104:107], v130 offset:3616
    v_mfma_f32_32x32x16_bf16 v[152:167], v[44:47], v[36:39], v[152:167]
    ds_read2_b32 v[108:109], v131 offset0:40 offset1:41
    ds_read2_b32 v[110:111], v131 offset0:42 offset1:43
    s_waitcnt lgkmcnt(6)
    v_mfma_f32_32x32x16_bf16 v[136:151], v[48:51], v[52:55], v[136:151]
    ds_read2_b32 v[112:113], v129 offset0:32 offset1:33
    ds_read2_b32 v[114:115], v129 offset0:34 offset1:35
    v_mfma_f32_32x32x16_bf16 v[152:167], v[48:51], v[56:59], v[152:167]
    ds_read_b128 v[116:119], v130 offset:32
    ds_read_b128 v[120:123], v130 offset:544
    v_mfma_f32_32x32x16_bf16 v[152:167], v[60:63], v[52:55], v[152:167]
    ds_read2_b32 v[124:125], v131 offset0:32 offset1:33
    ds_read2_b32 v[126:127], v131 offset0:34 offset1:35
    s_waitcnt lgkmcnt(6)
    v_mfma_f32_32x32x16_bf16 v[136:151], v[96:99], v[100:103], v[136:151]
    ds_read2_b32 v[32:33], v129 offset0:24 offset1:25
    ds_read2_b32 v[34:35], v129 offset0:26 offset1:27
    v_mfma_f32_32x32x16_bf16 v[152:167], v[96:99], v[104:107], v[152:167]
    ds_read_b128 v[36:39], v130 offset:3088
    ds_read_b128 v[40:43], v130 offset:3600
    v_mfma_f32_32x32x16_bf16 v[152:167], v[108:111], v[100:103], v[152:167]
    ds_read2_b32 v[44:45], v131 offset0:24 offset1:25
    ds_read2_b32 v[46:47], v131 offset0:26 offset1:27
    s_waitcnt lgkmcnt(6)
    v_mfma_f32_32x32x16_bf16 v[136:151], v[112:115], v[116:119], v[136:151]
    ds_read2_b32 v[48:49], v129 offset0:16 offset1:17
    ds_read2_b32 v[50:51], v129 offset0:18 offset1:19
    v_mfma_f32_32x32x16_bf16 v[152:167], v[112:115], v[120:123], v[152:167]
    ds_read_b128 v[52:55], v130 offset:16
    ds_read_b128 v[56:59], v130 offset:528
    v_mfma_f32_32x32x16_bf16 v[152:167], v[124:127], v[116:119], v[152:167]
    ds_read2_b32 v[60:61], v131 offset0:16 offset1:17
    ds_read2_b32 v[62:63], v131 offset0:18 offset1:19
    s_waitcnt lgkmcnt(6)
    v_mfma_f32_32x32x16_bf16 v[136:151], v[32:35], v[36:39], v[136:151]
    ds_read2_b32 v[96:97], v129 offset0:8 offset1:9
    ds_read2_b32 v[98:99], v129 offset0:10 offset1:11
    v_mfma_f32_32x32x16_bf16 v[152:167], v[32:35], v[40:43], v[152:167]
    ds_read_b128 v[100:103], v130 offset:3072
    ds_read_b128 v[104:107], v130 offset:3584
    v_mfma_f32_32x32x16_bf16 v[152:167], v[44:47], v[36:39], v[152:167]
    ds_read2_b32 v[108:109], v131 offset0:8 offset1:9
    ds_read2_b32 v[110:111], v131 offset0:10 offset1:11
    s_waitcnt lgkmcnt(6)
    v_mfma_f32_32x32x16_bf16 v[136:151], v[48:51], v[52:55], v[136:151]
    ds_read2_b32 v[112:113], v129 offset0:0 offset1:1
    ds_read2_b32 v[114:115], v129 offset0:2 offset1:3
    v_subrev_u32 v129, 256, v129
    v_mfma_f32_32x32x16_bf16 v[152:167], v[48:51], v[56:59], v[152:167]
    ds_read_b128 v[116:119], v130 offset:0
    ds_read_b128 v[120:123], v130 offset:512
    v_subrev_u32 v130, 64, v130
    v_mfma_f32_32x32x16_bf16 v[152:167], v[60:63], v[52:55], v[152:167]
    ds_read2_b32 v[124:125], v131 offset0:0 offset1:1
    ds_read2_b32 v[126:127], v131 offset0:2 offset1:3
    v_subrev_u32 v131, 256, v131
    s_sub_u32 s59, s59, 1
    s_cmp_lg_u32 s59, 0
    s_waitcnt lgkmcnt(6)
    v_mfma_f32_32x32x16_bf16 v[136:151], v[96:99], v[100:103], v[136:151]
    ds_read2_b32 v[32:33], v129 offset0:56 offset1:57
    ds_read2_b32 v[34:35], v129 offset0:58 offset1:59
    v_mfma_f32_32x32x16_bf16 v[152:167], v[96:99], v[104:107], v[152:167]
    ds_read_b128 v[36:39], v130 offset:3120
    ds_read_b128 v[40:43], v130 offset:3632
    v_mfma_f32_32x32x16_bf16 v[152:167], v[108:111], v[100:103], v[152:167]
    ds_read2_b32 v[44:45], v131 offset0:56 offset1:57
    ds_read2_b32 v[46:47], v131 offset0:58 offset1:59
    s_waitcnt lgkmcnt(6)
    v_mfma_f32_32x32x16_bf16 v[136:151], v[112:115], v[116:119], v[136:151]
    ds_read2_b32 v[48:49], v129 offset0:48 offset1:49
    ds_read2_b32 v[50:51], v129 offset0:50 offset1:51
    v_mfma_f32_32x32x16_bf16 v[152:167], v[112:115], v[120:123], v[152:167]
    ds_read_b128 v[52:55], v130 offset:48
    ds_read_b128 v[56:59], v130 offset:560
    v_mfma_f32_32x32x16_bf16 v[152:167], v[124:127], v[116:119], v[152:167]
    ds_read2_b32 v[60:61], v131 offset0:48 offset1:49
    ds_read2_b32 v[62:63], v131 offset0:50 offset1:51
    s_cbranch_scc1 L_CL0
L_CV1:
    s_setprio 0
    s_and_b32 s57, s3, 3
    s_lshl_b32 s57, s57, 12
    s_add_u32 s58, s57, 0
    v_add_u32 v132, s58, v1
    s_xor_b32 s57, s57, 4096
    s_add_u32 s58, s57, 0
    v_add_u32 v133, s58, v1
    s_lshl_b32 s62, s53, 12
    s_lshl_b32 s58, s52, 11
    s_add_u32 s62, s62, s58
    s_add_u32 s62, s62, 10878976
    s_waitcnt lgkmcnt(0)
    s_mov_b64 s[14:15], -1
    s_mov_b64 s[16:17], s[12:13]
    s_setprio 1
    v_mov_b32 v31, 163328
    v_mov_b32 v131, 1
    s_barrier
L_PRO1:
    ds_read_b128 v[12:15], v29
    ds_read_b128 v[4:7], v128
    ds_read_b128 v[8:11], v128 offset:1024
    s_mov_b64 exec, s[16:17]
    ds_read_b128 v[20:23], v30
    s_mov_b64 exec, s[14:15]
    s_waitcnt lgkmcnt(2)
    v_mfma_f32_32x32x16_bf16 v[32:47], v[12:15], v[4:7], 0
    s_waitcnt lgkmcnt(0)
    v_mfma_f32_32x32x16_bf16 v[48:63], v[12:15], v[8:11], 0
    ds_write_b128 v132, v[152:155] offset:0
    ds_write_b128 v132, v[156:159] offset:1024
    ds_write_b128 v132, v[160:163] offset:2048
    ds_write_b128 v132, v[164:167] offset:3072
    s_nop 5
    v_max3_f32 v128, v32, v33, v34
    v_max3_f32 v128, v128, v35, v36
    v_max3_f32 v128, v128, v37, v38
    v_max3_f32 v128, v128, v39, v40
    v_max3_f32 v128, v128, v41, v42
    v_max3_f32 v128, v128, v43, v44
    v_max3_f32 v128, v128, v45, v46
    v_max_f32 v128, v128, v47
    v_max3_f32 v129, v48, v49, v50
    v_max3_f32 v129, v129, v51, v52
    v_max3_f32 v129, v129, v53, v54
    v_max3_f32 v129, v129, v55, v56
    v_max3_f32 v129, v129, v57, v58
    v_max3_f32 v129, v129, v59, v60
    v_max3_f32 v129, v129, v61, v62
    v_max_f32 v129, v129, v63
    v_mov_b32 v130, v128
    s_nop 1
    v_permlane32_swap_b32 v128, v130
    v_max_f32 v128, v128, v130
    v_sub_f32 v96, 0, v128
    v_sub_f32 v97, 0, v128
    v_pk_mov_b32 v[98:99], v[96:97], v[96:97] op_sel:[0,1]
    v_pk_mov_b32 v[100:101], v[96:97], v[96:97] op_sel:[0,1]
    v_pk_mov_b32 v[102:103], v[96:97], v[96:97] op_sel:[0,1]
    v_pk_mov_b32 v[104:105], v[96:97], v[96:97] op_sel:[0,1]
    v_pk_mov_b32 v[106:107], v[96:97], v[96:97] op_sel:[0,1]
    v_pk_mov_b32 v[108:109], v[96:97], v[96:97] op_sel:[0,1]
    v_pk_mov_b32 v[110:111], v[96:97], v[96:97] op_sel:[0,1]
    s_nop 1
    v_mfma_f32_32x32x16_bf16 v[32:47], v[12:15], v[4:7], v[96:111]
    v_mov_b32 v130, v129
    s_nop 1
    v_permlane32_swap_b32 v129, v130
    v_max_f32 v129, v129, v130
    v_sub_f32 v112, 0, v129
    v_sub_f32 v113, 0, v129
    v_pk_mov_b32 v[114:115], v[112:113], v[112:113] op_sel:[0,1]
    v_pk_mov_b32 v[116:117], v[112:113], v[112:113] op_sel:[0,1]
    v_pk_mov_b32 v[118:119], v[112:113], v[112:113] op_sel:[0,1]
    v_pk_mov_b32 v[120:121], v[112:113], v[112:113] op_sel:[0,1]
    v_pk_mov_b32 v[122:123], v[112:113], v[112:113] op_sel:[0,1]
    v_pk_mov_b32 v[124:125], v[112:113], v[112:113] op_sel:[0,1]
    v_pk_mov_b32 v[126:127], v[112:113], v[112:113] op_sel:[0,1]
    s_setprio 1
    v_exp_f32 v32, v32
    v_exp_f32 v33, v33
    s_mov_b64 exec, s[12:13]
    ds_read_b128 v[16:19], v30 offset:512
    ds_read_b128 v[24:27], v30 offset:1024
    s_mov_b64 exec, -1
    v_exp_f32 v34, v34
    v_exp_f32 v35, v35
    v_exp_f32 v36, v36
    v_exp_f32 v37, v37
    v_mfma_f32_32x32x16_bf16 v[48:63], v[12:15], v[8:11], v[112:127]
    ds_read_b128 v[12:15], v29 offset:1024
    v_exp_f32 v38, v38
    v_exp_f32 v39, v39
    v_exp_f32 v40, v40
    v_exp_f32 v41, v41
    v_exp_f32 v42, v42
    v_smfmac_f32_32x32x32_bf16 v[64:79], v[20:23], v[32:39], v28
    v_exp_f32 v43, v43
    v_exp_f32 v44, v44
    v_exp_f32 v45, v45
    v_exp_f32 v46, v46
    v_exp_f32 v47, v47
    v_exp_f32 v48, v48
    s_waitcnt lgkmcnt(0)
    v_exp_f32 v49, v49
    v_smfmac_f32_32x32x32_bf16 v[64:79], v[16:19], v[40:47], v28
    v_exp_f32 v50, v50
    v_exp_f32 v51, v51
    v_exp_f32 v52, v52
    v_mfma_f32_32x32x16_bf16 v[32:47], v[12:15], v[4:7], v[96:111]
    v_exp_f32 v53, v53
    v_exp_f32 v54, v54
    v_exp_f32 v55, v55
    v_exp_f32 v56, v56
    v_exp_f32 v57, v57
    v_exp_f32 v58, v58
    v_smfmac_f32_32x32x32_bf16 v[80:95], v[20:23], v[48:55], v28
    s_setprio 0
    v_exp_f32 v59, v59
    v_exp_f32 v60, v60
    v_exp_f32 v61, v61
    v_exp_f32 v62, v62
    s_setprio 1
    v_exp_f32 v63, v63
    s_barrier
    ds_read_b128 v[152:155], v133 offset:0
    ds_read_b128 v[156:159], v133 offset:1024
    ds_read_b128 v[160:163], v133 offset:2048
    ds_read_b128 v[164:167], v133 offset:3072
    v_exp_f32 v32, v32
    v_exp_f32 v33, v33
    v_smfmac_f32_32x32x32_bf16 v[80:95], v[16:19], v[56:63], v28
    s_mov_b64 exec, s[12:13]
    ds_read_b128 v[16:19], v30 offset:1536
    ds_read_b128 v[20:23], v30 offset:2048
    s_mov_b64 exec, -1
    v_exp_f32 v34, v34
    v_exp_f32 v35, v35
    v_exp_f32 v36, v36
    v_exp_f32 v37, v37
    v_mfma_f32_32x32x16_bf16 v[48:63], v[12:15], v[8:11], v[112:127]
    ds_read_b128 v[12:15], v29 offset:2048
    v_exp_f32 v38, v38
    v_exp_f32 v39, v39
    v_exp_f32 v40, v40
    v_exp_f32 v41, v41
    v_exp_f32 v42, v42
    v_smfmac_f32_32x32x32_bf16 v[64:79], v[24:27], v[32:39], v28
    v_exp_f32 v43, v43
    v_exp_f32 v44, v44
    v_exp_f32 v45, v45
    v_exp_f32 v46, v46
    v_exp_f32 v47, v47
    s_waitcnt lgkmcnt(0)
    v_pk_add_f32 v[136:137], v[136:137], v[152:153]
    v_pk_add_f32 v[138:139], v[138:139], v[154:155]
    v_pk_add_f32 v[140:141], v[140:141], v[156:157]
    v_pk_add_f32 v[142:143], v[142:143], v[158:159]
    v_pk_add_f32 v[144:145], v[144:145], v[160:161]
    v_pk_add_f32 v[146:147], v[146:147], v[162:163]
    v_pk_add_f32 v[148:149], v[148:149], v[164:165]
    v_pk_add_f32 v[150:151], v[150:151], v[166:167]
    v_cvt_pk_bf16_f32 v152, v136, v137
    v_cvt_pk_bf16_f32 v153, v138, v139
    v_cvt_pk_bf16_f32 v154, v140, v141
    v_cvt_pk_bf16_f32 v155, v142, v143
    v_cvt_pk_bf16_f32 v156, v144, v145
    v_cvt_pk_bf16_f32 v157, v146, v147
    v_cvt_pk_bf16_f32 v158, v148, v149
    v_cvt_pk_bf16_f32 v159, v150, v151
    ds_write_b128 v132, v[152:155] offset:16384
    ds_write_b128 v132, v[156:159] offset:17408
    v_exp_f32 v48, v48
    s_waitcnt lgkmcnt(0)
    v_exp_f32 v49, v49
    v_smfmac_f32_32x32x32_bf16 v[64:79], v[16:19], v[40:47], v28
    v_exp_f32 v50, v50
    v_exp_f32 v51, v51
    v_exp_f32 v52, v52
    v_mfma_f32_32x32x16_bf16 v[32:47], v[12:15], v[4:7], v[96:111]
    v_exp_f32 v53, v53
    v_exp_f32 v54, v54
    v_exp_f32 v55, v55
    v_exp_f32 v56, v56
    v_exp_f32 v57, v57
    v_exp_f32 v58, v58
    v_smfmac_f32_32x32x32_bf16 v[80:95], v[24:27], v[48:55], v28
    s_setprio 0
    v_exp_f32 v59, v59
    v_exp_f32 v60, v60
    v_exp_f32 v61, v61
    v_exp_f32 v62, v62
    s_setprio 1
    v_exp_f32 v63, v63
    v_exp_f32 v32, v32
    v_exp_f32 v33, v33
    v_smfmac_f32_32x32x32_bf16 v[80:95], v[16:19], v[56:63], v28
    s_mov_b64 exec, s[12:13]
    ds_read_b128 v[16:19], v30 offset:2560
    ds_read_b128 v[24:27], v30 offset:3072
    s_mov_b64 exec, -1
    v_exp_f32 v34, v34
    v_exp_f32 v35, v35
    v_exp_f32 v36, v36
    v_exp_f32 v37, v37
    v_mfma_f32_32x32x16_bf16 v[48:63], v[12:15], v[8:11], v[112:127]
    ds_read_b128 v[12:15], v29 offset:3072
    v_exp_f32 v38, v38
    v_exp_f32 v39, v39
    v_exp_f32 v40, v40
    v_exp_f32 v41, v41
    v_exp_f32 v42, v42
    v_smfmac_f32_32x32x32_bf16 v[64:79], v[20:23], v[32:39], v28
    v_exp_f32 v43, v43
    v_exp_f32 v44, v44
    v_exp_f32 v45, v45
    v_exp_f32 v46, v46
    v_exp_f32 v47, v47
    v_exp_f32 v48, v48
    s_waitcnt lgkmcnt(0)
    v_exp_f32 v49, v49
    v_smfmac_f32_32x32x32_bf16 v[64:79], v[16:19], v[40:47], v28
    v_exp_f32 v50, v50
    v_exp_f32 v51, v51
    v_exp_f32 v52, v52
    v_mfma_f32_32x32x16_bf16 v[32:47], v[12:15], v[4:7], v[96:111]
    v_exp_f32 v53, v53
    v_exp_f32 v54, v54
    v_exp_f32 v55, v55
    v_exp_f32 v56, v56
    v_exp_f32 v57, v57
    v_exp_f32 v58, v58
    v_smfmac_f32_32x32x32_bf16 v[80:95], v[20:23], v[48:55], v28
    s_setprio 0
    v_exp_f32 v59, v59
    v_exp_f32 v60, v60
    v_exp_f32 v61, v61
    v_exp_f32 v62, v62
    s_setprio 1
    v_exp_f32 v63, v63
    v_exp_f32 v32, v32
    v_exp_f32 v33, v33
    v_smfmac_f32_32x32x32_bf16 v[80:95], v[16:19], v[56:63], v28
    s_mov_b64 exec, s[12:13]
    ds_read_b128 v[16:19], v30 offset:3584
    ds_read_b128 v[20:23], v30 offset:4096
    s_mov_b64 exec, -1
    v_exp_f32 v34, v34
    v_exp_f32 v35, v35
    v_exp_f32 v36, v36
    v_exp_f32 v37, v37
    v_mfma_f32_32x32x16_bf16 v[48:63], v[12:15], v[8:11], v[112:127]
    ds_read_b128 v[12:15], v29 offset:4096
    v_exp_f32 v38, v38
    v_exp_f32 v39, v39
    v_exp_f32 v40, v40
    v_exp_f32 v41, v41
    v_exp_f32 v42, v42
    v_smfmac_f32_32x32x32_bf16 v[64:79], v[24:27], v[32:39], v28
    v_exp_f32 v43, v43
    v_exp_f32 v44, v44
    v_exp_f32 v45, v45
    v_exp_f32 v46, v46
    v_exp_f32 v47, v47
    v_exp_f32 v48, v48
    s_waitcnt lgkmcnt(0)
    v_exp_f32 v49, v49
    v_smfmac_f32_32x32x32_bf16 v[64:79], v[16:19], v[40:47], v28
    v_exp_f32 v50, v50
    v_exp_f32 v51, v51
    v_exp_f32 v52, v52
    v_mfma_f32_32x32x16_bf16 v[32:47], v[12:15], v[4:7], v[96:111]
    v_exp_f32 v53, v53
    v_exp_f32 v54, v54
    v_exp_f32 v55, v55
    v_exp_f32 v56, v56
    v_exp_f32 v57, v57
    v_exp_f32 v58, v58
    v_smfmac_f32_32x32x32_bf16 v[80:95], v[24:27], v[48:55], v28
    s_setprio 0
    v_exp_f32 v59, v59
    v_exp_f32 v60, v60
    v_exp_f32 v61, v61
    v_exp_f32 v62, v62
    s_setprio 1
    v_exp_f32 v63, v63
    v_exp_f32 v32, v32
    v_exp_f32 v33, v33
    v_smfmac_f32_32x32x32_bf16 v[80:95], v[16:19], v[56:63], v28
    s_mov_b64 exec, s[12:13]
    ds_read_b128 v[16:19], v30 offset:4608
    ds_read_b128 v[24:27], v30 offset:5120
    s_mov_b64 exec, -1
    v_exp_f32 v34, v34
    v_exp_f32 v35, v35
    v_exp_f32 v36, v36
    v_exp_f32 v37, v37
    v_mfma_f32_32x32x16_bf16 v[48:63], v[12:15], v[8:11], v[112:127]
    ds_read_b128 v[12:15], v29 offset:5120
    v_exp_f32 v38, v38
    v_exp_f32 v39, v39
    v_exp_f32 v40, v40
    v_exp_f32 v41, v41
    v_exp_f32 v42, v42
    v_smfmac_f32_32x32x32_bf16 v[64:79], v[20:23], v[32:39], v28
    v_exp_f32 v43, v43
    v_exp_f32 v44, v44
    v_exp_f32 v45, v45
    v_exp_f32 v46, v46
    v_exp_f32 v47, v47
    v_exp_f32 v48, v48
    s_waitcnt lgkmcnt(0)
    v_exp_f32 v49, v49
    v_smfmac_f32_32x32x32_bf16 v[64:79], v[16:19], v[40:47], v28
    v_exp_f32 v50, v50
    v_exp_f32 v51, v51
    v_exp_f32 v52, v52
    v_mfma_f32_32x32x16_bf16 v[32:47], v[12:15], v[4:7], v[96:111]
    v_exp_f32 v53, v53
    v_exp_f32 v54, v54
    v_exp_f32 v55, v55
    v_exp_f32 v56, v56
    v_exp_f32 v57, v57
    v_exp_f32 v58, v58
    v_smfmac_f32_32x32x32_bf16 v[80:95], v[20:23], v[48:55], v28
    s_setprio 0
    v_exp_f32 v59, v59
    v_exp_f32 v60, v60
    v_exp_f32 v61, v61
    v_exp_f32 v62, v62
    s_setprio 1
    v_exp_f32 v63, v63
    v_exp_f32 v32, v32
    v_exp_f32 v33, v33
    v_smfmac_f32_32x32x32_bf16 v[80:95], v[16:19], v[56:63], v28
    s_mov_b64 exec, s[12:13]
    ds_read_b128 v[16:19], v30 offset:5632
    ds_read_b128 v[20:23], v30 offset:6144
    s_mov_b64 exec, -1
    v_exp_f32 v34, v34
    v_exp_f32 v35, v35
    v_exp_f32 v36, v36
    v_exp_f32 v37, v37
    v_mfma_f32_32x32x16_bf16 v[48:63], v[12:15], v[8:11], v[112:127]
    ds_read_b128 v[12:15], v29 offset:6144
    v_exp_f32 v38, v38
    v_exp_f32 v39, v39
    v_exp_f32 v40, v40
    v_exp_f32 v41, v41
    v_exp_f32 v42, v42
    v_smfmac_f32_32x32x32_bf16 v[64:79], v[24:27], v[32:39], v28
    v_exp_f32 v43, v43
    v_exp_f32 v44, v44
    v_exp_f32 v45, v45
    v_exp_f32 v46, v46
    v_exp_f32 v47, v47
    v_exp_f32 v48, v48
    s_waitcnt lgkmcnt(0)
    v_exp_f32 v49, v49
    v_smfmac_f32_32x32x32_bf16 v[64:79], v[16:19], v[40:47], v28
    v_exp_f32 v50, v50
    v_exp_f32 v51, v51
    v_exp_f32 v52, v52
    v_mfma_f32_32x32x16_bf16 v[32:47], v[12:15], v[4:7], v[96:111]
    v_exp_f32 v53, v53
    v_exp_f32 v54, v54
    v_exp_f32 v55, v55
    v_exp_f32 v56, v56
    v_exp_f32 v57, v57
    v_exp_f32 v58, v58
    v_smfmac_f32_32x32x32_bf16 v[80:95], v[24:27], v[48:55], v28
    s_setprio 0
    v_exp_f32 v59, v59
    v_exp_f32 v60, v60
    v_exp_f32 v61, v61
    v_exp_f32 v62, v62
    s_setprio 1
    v_exp_f32 v63, v63
    v_exp_f32 v32, v32
    v_exp_f32 v33, v33
    v_smfmac_f32_32x32x32_bf16 v[80:95], v[16:19], v[56:63], v28
    s_mov_b64 exec, s[12:13]
    ds_read_b128 v[16:19], v30 offset:6656
    ds_read_b128 v[24:27], v30 offset:7168
    s_mov_b64 exec, -1
    v_exp_f32 v34, v34
    v_exp_f32 v35, v35
    v_exp_f32 v36, v36
    v_exp_f32 v37, v37
    v_mfma_f32_32x32x16_bf16 v[48:63], v[12:15], v[8:11], v[112:127]
    ds_read_b128 v[12:15], v29 offset:7168
    v_exp_f32 v38, v38
    v_exp_f32 v39, v39
    v_exp_f32 v40, v40
    v_exp_f32 v41, v41
    v_exp_f32 v42, v42
    v_smfmac_f32_32x32x32_bf16 v[64:79], v[20:23], v[32:39], v28
    v_exp_f32 v43, v43
    v_exp_f32 v44, v44
    v_exp_f32 v45, v45
    v_exp_f32 v46, v46
    v_exp_f32 v47, v47
    v_exp_f32 v48, v48
    s_waitcnt lgkmcnt(0)
    v_exp_f32 v49, v49
    v_smfmac_f32_32x32x32_bf16 v[64:79], v[16:19], v[40:47], v28
    v_exp_f32 v50, v50
    v_exp_f32 v51, v51
    v_exp_f32 v52, v52
    v_mfma_f32_32x32x16_bf16 v[32:47], v[12:15], v[4:7], v[96:111]
    v_exp_f32 v53, v53
    v_exp_f32 v54, v54
    v_exp_f32 v55, v55
    v_exp_f32 v56, v56
    v_exp_f32 v57, v57
    v_exp_f32 v58, v58
    v_smfmac_f32_32x32x32_bf16 v[80:95], v[20:23], v[48:55], v28
    s_setprio 0
    v_exp_f32 v59, v59
    v_exp_f32 v60, v60
    v_exp_f32 v61, v61
    v_exp_f32 v62, v62
    s_setprio 1
    v_exp_f32 v63, v63
    s_barrier
    v_exp_f32 v32, v32
    v_exp_f32 v33, v33
    v_smfmac_f32_32x32x32_bf16 v[80:95], v[16:19], v[56:63], v28
    s_mov_b64 exec, s[12:13]
    ds_read_b128 v[16:19], v30 offset:7680
    ds_read_b128 v[20:23], v30 offset:8192
    s_mov_b64 exec, -1
    v_exp_f32 v34, v34
    v_exp_f32 v35, v35
    v_exp_f32 v36, v36
    v_exp_f32 v37, v37
    v_mfma_f32_32x32x16_bf16 v[48:63], v[12:15], v[8:11], v[112:127]
    ds_read_b128 v[12:15], v29 offset:8192
    v_exp_f32 v38, v38
    v_exp_f32 v39, v39
    v_exp_f32 v40, v40
    v_exp_f32 v41, v41
    v_exp_f32 v42, v42
    v_smfmac_f32_32x32x32_bf16 v[64:79], v[24:27], v[32:39], v28
    v_exp_f32 v43, v43
    v_exp_f32 v44, v44
    v_exp_f32 v45, v45
    v_exp_f32 v46, v46
    v_exp_f32 v47, v47
    v_exp_f32 v48, v48
    s_waitcnt lgkmcnt(0)
    v_exp_f32 v49, v49
    v_smfmac_f32_32x32x32_bf16 v[64:79], v[16:19], v[40:47], v28
    v_exp_f32 v50, v50
    v_exp_f32 v51, v51
    v_exp_f32 v52, v52
    v_mfma_f32_32x32x16_bf16 v[32:47], v[12:15], v[4:7], v[96:111]
    v_exp_f32 v53, v53
    v_exp_f32 v54, v54
    v_exp_f32 v55, v55
    v_exp_f32 v56, v56
    v_exp_f32 v57, v57
    v_exp_f32 v58, v58
    v_smfmac_f32_32x32x32_bf16 v[80:95], v[24:27], v[48:55], v28
    s_setprio 0
    v_exp_f32 v59, v59
    v_exp_f32 v60, v60
    v_exp_f32 v61, v61
    v_exp_f32 v62, v62
    s_setprio 1
    v_exp_f32 v63, v63
    v_exp_f32 v32, v32
    v_exp_f32 v33, v33
    v_smfmac_f32_32x32x32_bf16 v[80:95], v[16:19], v[56:63], v28
    s_mov_b64 exec, s[12:13]
    ds_read_b128 v[16:19], v30 offset:8704
    ds_read_b128 v[24:27], v30 offset:9216
    s_mov_b64 exec, -1
    v_exp_f32 v34, v34
    v_exp_f32 v35, v35
    v_exp_f32 v36, v36
    v_exp_f32 v37, v37
    v_mfma_f32_32x32x16_bf16 v[48:63], v[12:15], v[8:11], v[112:127]
    ds_read_b128 v[12:15], v29 offset:9216
    v_exp_f32 v38, v38
    v_exp_f32 v39, v39
    v_exp_f32 v40, v40
    v_exp_f32 v41, v41
    v_exp_f32 v42, v42
    v_smfmac_f32_32x32x32_bf16 v[64:79], v[20:23], v[32:39], v28
    v_exp_f32 v43, v43
    v_exp_f32 v44, v44
    v_exp_f32 v45, v45
    v_exp_f32 v46, v46
    v_exp_f32 v47, v47
    v_exp_f32 v48, v48
    s_waitcnt lgkmcnt(0)
    v_exp_f32 v49, v49
    v_smfmac_f32_32x32x32_bf16 v[64:79], v[16:19], v[40:47], v28
    v_exp_f32 v50, v50
    v_exp_f32 v51, v51
    v_exp_f32 v52, v52
    v_mfma_f32_32x32x16_bf16 v[32:47], v[12:15], v[4:7], v[96:111]
    v_exp_f32 v53, v53
    v_exp_f32 v54, v54
    v_exp_f32 v55, v55
    v_exp_f32 v56, v56
    v_exp_f32 v57, v57
    v_exp_f32 v58, v58
    v_smfmac_f32_32x32x32_bf16 v[80:95], v[20:23], v[48:55], v28
    s_setprio 0
    v_exp_f32 v59, v59
    v_exp_f32 v60, v60
    v_exp_f32 v61, v61
    v_exp_f32 v62, v62
    s_setprio 1
    v_exp_f32 v63, v63
    v_exp_f32 v32, v32
    v_exp_f32 v33, v33
    v_smfmac_f32_32x32x32_bf16 v[80:95], v[16:19], v[56:63], v28
    s_mov_b64 exec, s[12:13]
    ds_read_b128 v[16:19], v30 offset:9728
    ds_read_b128 v[20:23], v30 offset:10240
    s_mov_b64 exec, -1
    v_exp_f32 v34, v34
    v_exp_f32 v35, v35
    v_exp_f32 v36, v36
    v_exp_f32 v37, v37
    v_mfma_f32_32x32x16_bf16 v[48:63], v[12:15], v[8:11], v[112:127]
    ds_read_b128 v[12:15], v29 offset:10240
    v_exp_f32 v38, v38
    v_exp_f32 v39, v39
    v_exp_f32 v40, v40
    v_exp_f32 v41, v41
    v_exp_f32 v42, v42
    v_smfmac_f32_32x32x32_bf16 v[64:79], v[24:27], v[32:39], v28
    v_exp_f32 v43, v43
    v_exp_f32 v44, v44
    v_exp_f32 v45, v45
    v_exp_f32 v46, v46
    v_exp_f32 v47, v47
    v_exp_f32 v48, v48
    s_waitcnt lgkmcnt(0)
    v_exp_f32 v49, v49
    v_smfmac_f32_32x32x32_bf16 v[64:79], v[16:19], v[40:47], v28
    v_exp_f32 v50, v50
    v_exp_f32 v51, v51
    v_exp_f32 v52, v52
    v_mfma_f32_32x32x16_bf16 v[32:47], v[12:15], v[4:7], v[96:111]
    v_exp_f32 v53, v53
    v_exp_f32 v54, v54
    v_exp_f32 v55, v55
    v_exp_f32 v56, v56
    v_exp_f32 v57, v57
    v_exp_f32 v58, v58
    v_smfmac_f32_32x32x32_bf16 v[80:95], v[24:27], v[48:55], v28
    s_setprio 0
    v_exp_f32 v59, v59
    v_exp_f32 v60, v60
    v_exp_f32 v61, v61
    v_exp_f32 v62, v62
    s_setprio 1
    v_exp_f32 v63, v63
    v_exp_f32 v32, v32
    v_exp_f32 v33, v33
    v_smfmac_f32_32x32x32_bf16 v[80:95], v[16:19], v[56:63], v28
    s_mov_b64 exec, s[12:13]
    ds_read_b128 v[16:19], v30 offset:10752
    ds_read_b128 v[24:27], v30 offset:11264
    s_mov_b64 exec, -1
    v_exp_f32 v34, v34
    v_exp_f32 v35, v35
    v_exp_f32 v36, v36
    v_exp_f32 v37, v37
    v_mfma_f32_32x32x16_bf16 v[48:63], v[12:15], v[8:11], v[112:127]
    ds_read_b128 v[12:15], v29 offset:11264
    v_exp_f32 v38, v38
    v_exp_f32 v39, v39
    v_exp_f32 v40, v40
    v_exp_f32 v41, v41
    v_exp_f32 v42, v42
    v_smfmac_f32_32x32x32_bf16 v[64:79], v[20:23], v[32:39], v28
    v_exp_f32 v43, v43
    v_exp_f32 v44, v44
    v_exp_f32 v45, v45
    v_exp_f32 v46, v46
    v_exp_f32 v47, v47
    v_exp_f32 v48, v48
    s_waitcnt lgkmcnt(0)
    v_exp_f32 v49, v49
    v_smfmac_f32_32x32x32_bf16 v[64:79], v[16:19], v[40:47], v28
    v_exp_f32 v50, v50
    v_exp_f32 v51, v51
    v_exp_f32 v52, v52
    v_mfma_f32_32x32x16_bf16 v[32:47], v[12:15], v[4:7], v[96:111]
    v_exp_f32 v53, v53
    v_exp_f32 v54, v54
    v_exp_f32 v55, v55
    v_exp_f32 v56, v56
    v_exp_f32 v57, v57
    v_exp_f32 v58, v58
    v_smfmac_f32_32x32x32_bf16 v[80:95], v[20:23], v[48:55], v28
    s_setprio 0
    v_exp_f32 v59, v59
    v_exp_f32 v60, v60
    v_exp_f32 v61, v61
    v_exp_f32 v62, v62
    s_setprio 1
    v_exp_f32 v63, v63
    v_exp_f32 v32, v32
    v_exp_f32 v33, v33
    v_smfmac_f32_32x32x32_bf16 v[80:95], v[16:19], v[56:63], v28
    s_mov_b64 exec, s[12:13]
    ds_read_b128 v[16:19], v30 offset:11776
    ds_read_b128 v[20:23], v30 offset:12288
    s_mov_b64 exec, -1
    v_exp_f32 v34, v34
    v_exp_f32 v35, v35
    v_exp_f32 v36, v36
    v_exp_f32 v37, v37
    v_mfma_f32_32x32x16_bf16 v[48:63], v[12:15], v[8:11], v[112:127]
    ds_read_b128 v[12:15], v29 offset:12288
    v_exp_f32 v38, v38
    v_exp_f32 v39, v39
    v_exp_f32 v40, v40
    v_exp_f32 v41, v41
    v_exp_f32 v42, v42
    v_smfmac_f32_32x32x32_bf16 v[64:79], v[24:27], v[32:39], v28
    v_exp_f32 v43, v43
    v_exp_f32 v44, v44
    v_exp_f32 v45, v45
    v_exp_f32 v46, v46
    v_exp_f32 v47, v47
    v_exp_f32 v48, v48
    s_waitcnt lgkmcnt(0)
    v_exp_f32 v49, v49
    v_smfmac_f32_32x32x32_bf16 v[64:79], v[16:19], v[40:47], v28
    v_exp_f32 v50, v50
    v_exp_f32 v51, v51
    v_exp_f32 v52, v52
    v_mfma_f32_32x32x16_bf16 v[32:47], v[12:15], v[4:7], v[96:111]
    v_exp_f32 v53, v53
    v_exp_f32 v54, v54
    v_exp_f32 v55, v55
    v_exp_f32 v56, v56
    v_exp_f32 v57, v57
    v_exp_f32 v58, v58
    v_smfmac_f32_32x32x32_bf16 v[80:95], v[24:27], v[48:55], v28
    s_setprio 0
    v_exp_f32 v59, v59
    v_exp_f32 v60, v60
    v_exp_f32 v61, v61
    v_exp_f32 v62, v62
    s_setprio 1
    v_exp_f32 v63, v63
    v_exp_f32 v32, v32
    v_exp_f32 v33, v33
    v_smfmac_f32_32x32x32_bf16 v[80:95], v[16:19], v[56:63], v28
    s_mov_b64 exec, s[12:13]
    ds_read_b128 v[16:19], v30 offset:12800
    ds_read_b128 v[24:27], v30 offset:13312
    s_mov_b64 exec, -1
    v_exp_f32 v34, v34
    v_exp_f32 v35, v35
    v_exp_f32 v36, v36
    v_exp_f32 v37, v37
    v_mfma_f32_32x32x16_bf16 v[48:63], v[12:15], v[8:11], v[112:127]
    ds_read_b128 v[12:15], v29 offset:13312
    v_exp_f32 v38, v38
    v_exp_f32 v39, v39
    v_exp_f32 v40, v40
    v_exp_f32 v41, v41
    v_exp_f32 v42, v42
    v_smfmac_f32_32x32x32_bf16 v[64:79], v[20:23], v[32:39], v28
    v_exp_f32 v43, v43
    v_exp_f32 v44, v44
    v_exp_f32 v45, v45
    v_exp_f32 v46, v46
    v_exp_f32 v47, v47
    v_exp_f32 v48, v48
    s_waitcnt lgkmcnt(0)
    v_exp_f32 v49, v49
    v_smfmac_f32_32x32x32_bf16 v[64:79], v[16:19], v[40:47], v28
    v_exp_f32 v50, v50
    v_exp_f32 v51, v51
    v_exp_f32 v52, v52
    v_mfma_f32_32x32x16_bf16 v[32:47], v[12:15], v[4:7], v[96:111]
    v_exp_f32 v53, v53
    v_exp_f32 v54, v54
    v_exp_f32 v55, v55
    v_exp_f32 v56, v56
    v_exp_f32 v57, v57
    v_exp_f32 v58, v58
    v_smfmac_f32_32x32x32_bf16 v[80:95], v[20:23], v[48:55], v28
    s_setprio 0
    v_exp_f32 v59, v59
    v_exp_f32 v60, v60
    v_exp_f32 v61, v61
    v_exp_f32 v62, v62
    s_setprio 1
    v_exp_f32 v63, v63
    v_exp_f32 v32, v32
    v_exp_f32 v33, v33
    v_smfmac_f32_32x32x32_bf16 v[80:95], v[16:19], v[56:63], v28
    s_mov_b64 exec, s[12:13]
    ds_read_b128 v[16:19], v30 offset:13824
    ds_read_b128 v[20:23], v30 offset:14336
    s_mov_b64 exec, -1
    v_exp_f32 v34, v34
    v_exp_f32 v35, v35
    v_exp_f32 v36, v36
    v_exp_f32 v37, v37
    v_mfma_f32_32x32x16_bf16 v[48:63], v[12:15], v[8:11], v[112:127]
    ds_read_b128 v[12:15], v29 offset:14336
    v_exp_f32 v38, v38
    v_exp_f32 v39, v39
    v_exp_f32 v40, v40
    v_exp_f32 v41, v41
    v_exp_f32 v42, v42
    v_smfmac_f32_32x32x32_bf16 v[64:79], v[24:27], v[32:39], v28
    v_exp_f32 v43, v43
    v_exp_f32 v44, v44
    v_exp_f32 v45, v45
    v_exp_f32 v46, v46
    v_exp_f32 v47, v47
    v_exp_f32 v48, v48
    s_waitcnt lgkmcnt(0)
    v_exp_f32 v49, v49
    v_smfmac_f32_32x32x32_bf16 v[64:79], v[16:19], v[40:47], v28
    v_exp_f32 v50, v50
    v_exp_f32 v51, v51
    v_exp_f32 v52, v52
    v_mfma_f32_32x32x16_bf16 v[32:47], v[12:15], v[4:7], v[96:111]
    v_exp_f32 v53, v53
    v_exp_f32 v54, v54
    v_exp_f32 v55, v55
    v_exp_f32 v56, v56
    v_exp_f32 v57, v57
    v_exp_f32 v58, v58
    v_smfmac_f32_32x32x32_bf16 v[80:95], v[24:27], v[48:55], v28
    s_setprio 0
    v_exp_f32 v59, v59
    v_exp_f32 v60, v60
    v_exp_f32 v61, v61
    v_exp_f32 v62, v62
    s_setprio 1
    v_exp_f32 v63, v63
    v_exp_f32 v32, v32
    v_exp_f32 v33, v33
    v_smfmac_f32_32x32x32_bf16 v[80:95], v[16:19], v[56:63], v28
    s_mov_b64 exec, s[12:13]
    ds_read_b128 v[16:19], v30 offset:14848
    ds_read_b128 v[24:27], v30 offset:15360
    s_mov_b64 exec, -1
    v_exp_f32 v34, v34
    v_exp_f32 v35, v35
    v_exp_f32 v36, v36
    v_exp_f32 v37, v37
    v_mfma_f32_32x32x16_bf16 v[48:63], v[12:15], v[8:11], v[112:127]
    ds_read_b128 v[12:15], v29 offset:15360
    v_exp_f32 v38, v38
    v_exp_f32 v39, v39
    v_exp_f32 v40, v40
    v_exp_f32 v41, v41
    v_exp_f32 v42, v42
    v_smfmac_f32_32x32x32_bf16 v[64:79], v[20:23], v[32:39], v28
    v_exp_f32 v43, v43
    v_exp_f32 v44, v44
    v_exp_f32 v45, v45
    v_exp_f32 v46, v46
    v_exp_f32 v47, v47
    v_exp_f32 v48, v48
    s_waitcnt lgkmcnt(0)
    v_exp_f32 v49, v49
    v_smfmac_f32_32x32x32_bf16 v[64:79], v[16:19], v[40:47], v28
    v_exp_f32 v50, v50
    v_exp_f32 v51, v51
    v_exp_f32 v52, v52
    v_mfma_f32_32x32x16_bf16 v[32:47], v[12:15], v[4:7], v[96:111]
    v_exp_f32 v53, v53
    v_exp_f32 v54, v54
    v_exp_f32 v55, v55
    v_exp_f32 v56, v56
    v_exp_f32 v57, v57
    v_exp_f32 v58, v58
    v_smfmac_f32_32x32x32_bf16 v[80:95], v[20:23], v[48:55], v28
    s_setprio 0
    v_exp_f32 v59, v59
    v_exp_f32 v60, v60
    v_exp_f32 v61, v61
    v_exp_f32 v62, v62
    s_setprio 1
    v_exp_f32 v63, v63
    v_exp_f32 v32, v32
    v_exp_f32 v33, v33
    v_smfmac_f32_32x32x32_bf16 v[80:95], v[16:19], v[56:63], v28
    s_mov_b64 exec, s[12:13]
    ds_read_b128 v[16:19], v30 offset:15872
    ds_read_b128 v[20:23], v30 offset:16384
    s_mov_b64 exec, -1
    v_exp_f32 v34, v34
    v_exp_f32 v35, v35
    v_exp_f32 v36, v36
    v_exp_f32 v37, v37
    v_mfma_f32_32x32x16_bf16 v[48:63], v[12:15], v[8:11], v[112:127]
    ds_read_b128 v[12:15], v29 offset:16384
    v_exp_f32 v38, v38
    v_exp_f32 v39, v39
    v_exp_f32 v40, v40
    v_exp_f32 v41, v41
    v_exp_f32 v42, v42
    v_smfmac_f32_32x32x32_bf16 v[64:79], v[24:27], v[32:39], v28
    v_exp_f32 v43, v43
    v_exp_f32 v44, v44
    v_exp_f32 v45, v45
    v_exp_f32 v46, v46
    v_exp_f32 v47, v47
    v_exp_f32 v48, v48
    s_waitcnt lgkmcnt(0)
    v_exp_f32 v49, v49
    v_smfmac_f32_32x32x32_bf16 v[64:79], v[16:19], v[40:47], v28
    v_exp_f32 v50, v50
    v_exp_f32 v51, v51
    v_exp_f32 v52, v52
    v_mfma_f32_32x32x16_bf16 v[32:47], v[12:15], v[4:7], v[96:111]
    v_exp_f32 v53, v53
    v_exp_f32 v54, v54
    v_exp_f32 v55, v55
    v_exp_f32 v56, v56
    v_exp_f32 v57, v57
    v_exp_f32 v58, v58
    v_smfmac_f32_32x32x32_bf16 v[80:95], v[24:27], v[48:55], v28
    s_setprio 0
    v_exp_f32 v59, v59
    v_exp_f32 v60, v60
    v_exp_f32 v61, v61
    v_exp_f32 v62, v62
    s_setprio 1
    v_exp_f32 v63, v63
    v_exp_f32 v32, v32
    v_exp_f32 v33, v33
    v_smfmac_f32_32x32x32_bf16 v[80:95], v[16:19], v[56:63], v28
    s_mov_b64 exec, s[12:13]
    ds_read_b128 v[16:19], v30 offset:16896
    ds_read_b128 v[24:27], v30 offset:17408
    s_mov_b64 exec, -1
    v_exp_f32 v34, v34
    v_exp_f32 v35, v35
    v_exp_f32 v36, v36
    v_exp_f32 v37, v37
    v_mfma_f32_32x32x16_bf16 v[48:63], v[12:15], v[8:11], v[112:127]
    ds_read_b128 v[12:15], v29 offset:17408
    v_exp_f32 v38, v38
    v_exp_f32 v39, v39
    v_exp_f32 v40, v40
    v_exp_f32 v41, v41
    v_exp_f32 v42, v42
    v_smfmac_f32_32x32x32_bf16 v[64:79], v[20:23], v[32:39], v28
    v_exp_f32 v43, v43
    v_exp_f32 v44, v44
    v_exp_f32 v45, v45
    v_exp_f32 v46, v46
    v_exp_f32 v47, v47
    v_exp_f32 v48, v48
    s_waitcnt lgkmcnt(0)
    v_exp_f32 v49, v49
    v_smfmac_f32_32x32x32_bf16 v[64:79], v[16:19], v[40:47], v28
    v_exp_f32 v50, v50
    v_exp_f32 v51, v51
    v_exp_f32 v52, v52
    v_mfma_f32_32x32x16_bf16 v[32:47], v[12:15], v[4:7], v[96:111]
    v_exp_f32 v53, v53
    v_exp_f32 v54, v54
    v_exp_f32 v55, v55
    v_exp_f32 v56, v56
    v_exp_f32 v57, v57
    v_exp_f32 v58, v58
    v_smfmac_f32_32x32x32_bf16 v[80:95], v[20:23], v[48:55], v28
    s_setprio 0
    v_exp_f32 v59, v59
    v_exp_f32 v60, v60
    v_exp_f32 v61, v61
    v_exp_f32 v62, v62
    s_setprio 1
    v_exp_f32 v63, v63
    v_exp_f32 v32, v32
    v_exp_f32 v33, v33
    v_smfmac_f32_32x32x32_bf16 v[80:95], v[16:19], v[56:63], v28
    s_mov_b64 exec, s[12:13]
    ds_read_b128 v[16:19], v30 offset:17920
    ds_read_b128 v[20:23], v30 offset:18432
    s_mov_b64 exec, -1
    v_exp_f32 v34, v34
    v_exp_f32 v35, v35
    v_exp_f32 v36, v36
    v_exp_f32 v37, v37
    v_mfma_f32_32x32x16_bf16 v[48:63], v[12:15], v[8:11], v[112:127]
    ds_read_b128 v[12:15], v29 offset:18432
    v_exp_f32 v38, v38
    v_exp_f32 v39, v39
    v_exp_f32 v40, v40
    v_exp_f32 v41, v41
    v_exp_f32 v42, v42
    v_smfmac_f32_32x32x32_bf16 v[64:79], v[24:27], v[32:39], v28
    v_exp_f32 v43, v43
    v_exp_f32 v44, v44
    v_exp_f32 v45, v45
    v_exp_f32 v46, v46
    v_exp_f32 v47, v47
    v_exp_f32 v48, v48
    s_waitcnt lgkmcnt(0)
    v_exp_f32 v49, v49
    v_smfmac_f32_32x32x32_bf16 v[64:79], v[16:19], v[40:47], v28
    v_exp_f32 v50, v50
    v_exp_f32 v51, v51
    v_exp_f32 v52, v52
    v_mfma_f32_32x32x16_bf16 v[32:47], v[12:15], v[4:7], v[96:111]
    v_exp_f32 v53, v53
    v_exp_f32 v54, v54
    v_exp_f32 v55, v55
    v_exp_f32 v56, v56
    v_exp_f32 v57, v57
    v_exp_f32 v58, v58
    v_smfmac_f32_32x32x32_bf16 v[80:95], v[24:27], v[48:55], v28
    s_setprio 0
    v_exp_f32 v59, v59
    v_exp_f32 v60, v60
    v_exp_f32 v61, v61
    v_exp_f32 v62, v62
    s_setprio 1
    v_exp_f32 v63, v63
    v_exp_f32 v32, v32
    v_exp_f32 v33, v33
    v_smfmac_f32_32x32x32_bf16 v[80:95], v[16:19], v[56:63], v28
    s_mov_b64 exec, s[12:13]
    ds_read_b128 v[16:19], v30 offset:18944
    ds_read_b128 v[24:27], v30 offset:19456
    s_mov_b64 exec, -1
    v_exp_f32 v34, v34
    v_exp_f32 v35, v35
    v_exp_f32 v36, v36
    v_exp_f32 v37, v37
    v_mfma_f32_32x32x16_bf16 v[48:63], v[12:15], v[8:11], v[112:127]
    ds_read_b128 v[12:15], v29 offset:19456
    v_exp_f32 v38, v38
    v_exp_f32 v39, v39
    v_exp_f32 v40, v40
    v_exp_f32 v41, v41
    v_exp_f32 v42, v42
    v_smfmac_f32_32x32x32_bf16 v[64:79], v[20:23], v[32:39], v28
    v_exp_f32 v43, v43
    v_exp_f32 v44, v44
    v_exp_f32 v45, v45
    v_exp_f32 v46, v46
    v_exp_f32 v47, v47
    v_exp_f32 v48, v48
    s_waitcnt lgkmcnt(0)
    v_exp_f32 v49, v49
    v_smfmac_f32_32x32x32_bf16 v[64:79], v[16:19], v[40:47], v28
    v_exp_f32 v50, v50
    v_exp_f32 v51, v51
    v_exp_f32 v52, v52
    v_mfma_f32_32x32x16_bf16 v[32:47], v[12:15], v[4:7], v[96:111]
    v_exp_f32 v53, v53
    v_exp_f32 v54, v54
    v_exp_f32 v55, v55
    v_exp_f32 v56, v56
    v_exp_f32 v57, v57
    v_exp_f32 v58, v58
    v_smfmac_f32_32x32x32_bf16 v[80:95], v[20:23], v[48:55], v28
    s_setprio 0
    v_exp_f32 v59, v59
    v_exp_f32 v60, v60
    v_exp_f32 v61, v61
    v_exp_f32 v62, v62
    s_setprio 1
    v_exp_f32 v63, v63
    v_exp_f32 v32, v32
    v_exp_f32 v33, v33
    v_smfmac_f32_32x32x32_bf16 v[80:95], v[16:19], v[56:63], v28
    s_mov_b64 exec, s[12:13]
    ds_read_b128 v[16:19], v30 offset:19968
    ds_read_b128 v[20:23], v30 offset:20480
    s_mov_b64 exec, -1
    v_exp_f32 v34, v34
    v_exp_f32 v35, v35
    v_exp_f32 v36, v36
    v_exp_f32 v37, v37
    v_mfma_f32_32x32x16_bf16 v[48:63], v[12:15], v[8:11], v[112:127]
    ds_read_b128 v[12:15], v29 offset:20480
    v_exp_f32 v38, v38
    v_exp_f32 v39, v39
    v_exp_f32 v40, v40
    v_exp_f32 v41, v41
    v_exp_f32 v42, v42
    v_smfmac_f32_32x32x32_bf16 v[64:79], v[24:27], v[32:39], v28
    v_exp_f32 v43, v43
    v_exp_f32 v44, v44
    v_exp_f32 v45, v45
    v_exp_f32 v46, v46
    v_exp_f32 v47, v47
    v_exp_f32 v48, v48
    s_waitcnt lgkmcnt(0)
    v_exp_f32 v49, v49
    v_smfmac_f32_32x32x32_bf16 v[64:79], v[16:19], v[40:47], v28
    v_exp_f32 v50, v50
    v_exp_f32 v51, v51
    v_exp_f32 v52, v52
    v_mfma_f32_32x32x16_bf16 v[32:47], v[12:15], v[4:7], v[96:111]
    v_exp_f32 v53, v53
    v_exp_f32 v54, v54
    v_exp_f32 v55, v55
    v_exp_f32 v56, v56
    v_exp_f32 v57, v57
    v_exp_f32 v58, v58
    v_smfmac_f32_32x32x32_bf16 v[80:95], v[24:27], v[48:55], v28
    s_setprio 0
    v_exp_f32 v59, v59
    v_exp_f32 v60, v60
    v_exp_f32 v61, v61
    v_exp_f32 v62, v62
    s_setprio 1
    v_exp_f32 v63, v63
    v_exp_f32 v32, v32
    v_exp_f32 v33, v33
    v_smfmac_f32_32x32x32_bf16 v[80:95], v[16:19], v[56:63], v28
    s_mov_b64 exec, s[12:13]
    ds_read_b128 v[16:19], v30 offset:20992
    ds_read_b128 v[24:27], v30 offset:21504
    s_mov_b64 exec, -1
    v_exp_f32 v34, v34
    v_exp_f32 v35, v35
    v_exp_f32 v36, v36
    v_exp_f32 v37, v37
    v_mfma_f32_32x32x16_bf16 v[48:63], v[12:15], v[8:11], v[112:127]
    ds_read_b128 v[12:15], v29 offset:21504
    v_exp_f32 v38, v38
    v_exp_f32 v39, v39
    v_exp_f32 v40, v40
    v_exp_f32 v41, v41
    v_exp_f32 v42, v42
    v_smfmac_f32_32x32x32_bf16 v[64:79], v[20:23], v[32:39], v28
    v_exp_f32 v43, v43
    v_exp_f32 v44, v44
    v_exp_f32 v45, v45
    v_exp_f32 v46, v46
    v_exp_f32 v47, v47
    v_exp_f32 v48, v48
    s_waitcnt lgkmcnt(0)
    v_exp_f32 v49, v49
    v_smfmac_f32_32x32x32_bf16 v[64:79], v[16:19], v[40:47], v28
    v_exp_f32 v50, v50
    v_exp_f32 v51, v51
    v_exp_f32 v52, v52
    v_mfma_f32_32x32x16_bf16 v[32:47], v[12:15], v[4:7], v[96:111]
    v_exp_f32 v53, v53
    v_exp_f32 v54, v54
    v_exp_f32 v55, v55
    v_exp_f32 v56, v56
    v_exp_f32 v57, v57
    v_exp_f32 v58, v58
    v_smfmac_f32_32x32x32_bf16 v[80:95], v[20:23], v[48:55], v28
    s_setprio 0
    v_exp_f32 v59, v59
    v_exp_f32 v60, v60
    v_exp_f32 v61, v61
    v_exp_f32 v62, v62
    s_setprio 1
    v_exp_f32 v63, v63
    v_exp_f32 v32, v32
    v_exp_f32 v33, v33
    v_smfmac_f32_32x32x32_bf16 v[80:95], v[16:19], v[56:63], v28
    s_mov_b64 exec, s[12:13]
    ds_read_b128 v[16:19], v30 offset:22016
    ds_read_b128 v[20:23], v30 offset:22528
    s_mov_b64 exec, -1
    v_exp_f32 v34, v34
    v_exp_f32 v35, v35
    v_exp_f32 v36, v36
    v_exp_f32 v37, v37
    v_mfma_f32_32x32x16_bf16 v[48:63], v[12:15], v[8:11], v[112:127]
    ds_read_b128 v[12:15], v29 offset:22528
    v_exp_f32 v38, v38
    v_exp_f32 v39, v39
    v_exp_f32 v40, v40
    v_exp_f32 v41, v41
    v_exp_f32 v42, v42
    v_smfmac_f32_32x32x32_bf16 v[64:79], v[24:27], v[32:39], v28
    v_exp_f32 v43, v43
    v_exp_f32 v44, v44
    v_exp_f32 v45, v45
    v_exp_f32 v46, v46
    v_exp_f32 v47, v47
    v_exp_f32 v48, v48
    s_waitcnt lgkmcnt(0)
    v_exp_f32 v49, v49
    v_smfmac_f32_32x32x32_bf16 v[64:79], v[16:19], v[40:47], v28
    v_exp_f32 v50, v50
    v_exp_f32 v51, v51
    v_exp_f32 v52, v52
    v_mfma_f32_32x32x16_bf16 v[32:47], v[12:15], v[4:7], v[96:111]
    v_exp_f32 v53, v53
    v_exp_f32 v54, v54
    v_exp_f32 v55, v55
    v_exp_f32 v56, v56
    v_exp_f32 v57, v57
    v_exp_f32 v58, v58
    v_smfmac_f32_32x32x32_bf16 v[80:95], v[24:27], v[48:55], v28
    s_setprio 0
    v_exp_f32 v59, v59
    v_exp_f32 v60, v60
    v_exp_f32 v61, v61
    v_exp_f32 v62, v62
    s_setprio 1
    v_exp_f32 v63, v63
    v_exp_f32 v32, v32
    v_exp_f32 v33, v33
    v_smfmac_f32_32x32x32_bf16 v[80:95], v[16:19], v[56:63], v28
    s_mov_b64 exec, s[12:13]
    ds_read_b128 v[16:19], v30 offset:23040
    ds_read_b128 v[24:27], v30 offset:23552
    s_mov_b64 exec, -1
    v_exp_f32 v34, v34
    v_exp_f32 v35, v35
    v_exp_f32 v36, v36
    v_exp_f32 v37, v37
    v_mfma_f32_32x32x16_bf16 v[48:63], v[12:15], v[8:11], v[112:127]
    ds_read_b128 v[12:15], v29 offset:23552
    v_exp_f32 v38, v38
    v_exp_f32 v39, v39
    v_exp_f32 v40, v40
    v_exp_f32 v41, v41
    v_exp_f32 v42, v42
    v_smfmac_f32_32x32x32_bf16 v[64:79], v[20:23], v[32:39], v28
    v_exp_f32 v43, v43
    v_exp_f32 v44, v44
    v_exp_f32 v45, v45
    v_exp_f32 v46, v46
    v_exp_f32 v47, v47
    v_exp_f32 v48, v48
    s_waitcnt lgkmcnt(0)
    v_exp_f32 v49, v49
    v_smfmac_f32_32x32x32_bf16 v[64:79], v[16:19], v[40:47], v28
    v_exp_f32 v50, v50
    v_exp_f32 v51, v51
    v_exp_f32 v52, v52
    v_mfma_f32_32x32x16_bf16 v[32:47], v[12:15], v[4:7], v[96:111]
    v_exp_f32 v53, v53
    v_exp_f32 v54, v54
    v_exp_f32 v55, v55
    v_exp_f32 v56, v56
    v_exp_f32 v57, v57
    v_exp_f32 v58, v58
    v_smfmac_f32_32x32x32_bf16 v[80:95], v[20:23], v[48:55], v28
    s_setprio 0
    v_exp_f32 v59, v59
    v_exp_f32 v60, v60
    v_exp_f32 v61, v61
    v_exp_f32 v62, v62
    s_setprio 1
    v_exp_f32 v63, v63
    v_exp_f32 v32, v32
    v_exp_f32 v33, v33
    v_smfmac_f32_32x32x32_bf16 v[80:95], v[16:19], v[56:63], v28
    s_mov_b64 exec, s[12:13]
    ds_read_b128 v[16:19], v30 offset:24064
    ds_read_b128 v[20:23], v30 offset:24576
    s_mov_b64 exec, -1
    v_exp_f32 v34, v34
    v_exp_f32 v35, v35
    v_exp_f32 v36, v36
    v_exp_f32 v37, v37
    v_mfma_f32_32x32x16_bf16 v[48:63], v[12:15], v[8:11], v[112:127]
    ds_read_b128 v[12:15], v29 offset:24576
    v_exp_f32 v38, v38
    v_exp_f32 v39, v39
    v_exp_f32 v40, v40
    v_exp_f32 v41, v41
    v_exp_f32 v42, v42
    v_smfmac_f32_32x32x32_bf16 v[64:79], v[24:27], v[32:39], v28
    v_exp_f32 v43, v43
    v_exp_f32 v44, v44
    v_exp_f32 v45, v45
    v_exp_f32 v46, v46
    v_exp_f32 v47, v47
    v_exp_f32 v48, v48
    s_waitcnt lgkmcnt(0)
    v_exp_f32 v49, v49
    v_smfmac_f32_32x32x32_bf16 v[64:79], v[16:19], v[40:47], v28
    v_exp_f32 v50, v50
    v_exp_f32 v51, v51
    v_exp_f32 v52, v52
    v_mfma_f32_32x32x16_bf16 v[32:47], v[12:15], v[4:7], v[96:111]
    v_exp_f32 v53, v53
    v_exp_f32 v54, v54
    v_exp_f32 v55, v55
    v_exp_f32 v56, v56
    v_exp_f32 v57, v57
    v_exp_f32 v58, v58
    v_smfmac_f32_32x32x32_bf16 v[80:95], v[24:27], v[48:55], v28
    s_setprio 0
    v_exp_f32 v59, v59
    v_exp_f32 v60, v60
    v_exp_f32 v61, v61
    v_exp_f32 v62, v62
    s_setprio 1
    v_exp_f32 v63, v63
    v_exp_f32 v32, v32
    v_exp_f32 v33, v33
    v_smfmac_f32_32x32x32_bf16 v[80:95], v[16:19], v[56:63], v28
    s_mov_b64 exec, s[12:13]
    ds_read_b128 v[16:19], v30 offset:25088
    ds_read_b128 v[24:27], v30 offset:25600
    s_mov_b64 exec, -1
    v_exp_f32 v34, v34
    v_exp_f32 v35, v35
    v_exp_f32 v36, v36
    v_exp_f32 v37, v37
    v_mfma_f32_32x32x16_bf16 v[48:63], v[12:15], v[8:11], v[112:127]
    ds_read_b128 v[12:15], v29 offset:25600
    v_exp_f32 v38, v38
    v_exp_f32 v39, v39
    v_exp_f32 v40, v40
    v_exp_f32 v41, v41
    v_exp_f32 v42, v42
    v_smfmac_f32_32x32x32_bf16 v[64:79], v[20:23], v[32:39], v28
    v_exp_f32 v43, v43
    v_exp_f32 v44, v44
    v_exp_f32 v45, v45
    v_exp_f32 v46, v46
    v_exp_f32 v47, v47
    v_exp_f32 v48, v48
    s_waitcnt lgkmcnt(0)
    v_exp_f32 v49, v49
    v_smfmac_f32_32x32x32_bf16 v[64:79], v[16:19], v[40:47], v28
    v_exp_f32 v50, v50
    v_exp_f32 v51, v51
    v_exp_f32 v52, v52
    v_mfma_f32_32x32x16_bf16 v[32:47], v[12:15], v[4:7], v[96:111]
    v_exp_f32 v53, v53
    v_exp_f32 v54, v54
    v_exp_f32 v55, v55
    v_exp_f32 v56, v56
    v_exp_f32 v57, v57
    v_exp_f32 v58, v58
    v_smfmac_f32_32x32x32_bf16 v[80:95], v[20:23], v[48:55], v28
    s_setprio 0
    v_exp_f32 v59, v59
    v_exp_f32 v60, v60
    v_exp_f32 v61, v61
    v_exp_f32 v62, v62
    s_setprio 1
    v_exp_f32 v63, v63
    v_exp_f32 v32, v32
    v_exp_f32 v33, v33
    v_smfmac_f32_32x32x32_bf16 v[80:95], v[16:19], v[56:63], v28
    s_mov_b64 exec, s[12:13]
    ds_read_b128 v[16:19], v30 offset:26112
    ds_read_b128 v[20:23], v30 offset:26624
    s_mov_b64 exec, -1
    v_exp_f32 v34, v34
    v_exp_f32 v35, v35
    v_exp_f32 v36, v36
    v_exp_f32 v37, v37
    v_mfma_f32_32x32x16_bf16 v[48:63], v[12:15], v[8:11], v[112:127]
    ds_read_b128 v[12:15], v29 offset:26624
    v_exp_f32 v38, v38
    v_exp_f32 v39, v39
    v_exp_f32 v40, v40
    v_exp_f32 v41, v41
    v_exp_f32 v42, v42
    v_smfmac_f32_32x32x32_bf16 v[64:79], v[24:27], v[32:39], v28
    v_exp_f32 v43, v43
    v_exp_f32 v44, v44
    v_exp_f32 v45, v45
    v_exp_f32 v46, v46
    v_exp_f32 v47, v47
    v_exp_f32 v48, v48
    s_waitcnt lgkmcnt(0)
    v_exp_f32 v49, v49
    v_smfmac_f32_32x32x32_bf16 v[64:79], v[16:19], v[40:47], v28
    v_exp_f32 v50, v50
    v_exp_f32 v51, v51
    v_exp_f32 v52, v52
    v_mfma_f32_32x32x16_bf16 v[32:47], v[12:15], v[4:7], v[96:111]
    v_exp_f32 v53, v53
    v_exp_f32 v54, v54
    v_exp_f32 v55, v55
    v_exp_f32 v56, v56
    v_exp_f32 v57, v57
    v_exp_f32 v58, v58
    v_smfmac_f32_32x32x32_bf16 v[80:95], v[24:27], v[48:55], v28
    s_setprio 0
    v_exp_f32 v59, v59
    v_exp_f32 v60, v60
    v_exp_f32 v61, v61
    v_exp_f32 v62, v62
    s_setprio 1
    v_exp_f32 v63, v63
    v_exp_f32 v32, v32
    v_exp_f32 v33, v33
    v_smfmac_f32_32x32x32_bf16 v[80:95], v[16:19], v[56:63], v28
    s_mov_b64 exec, s[12:13]
    ds_read_b128 v[16:19], v30 offset:27136
    ds_read_b128 v[24:27], v30 offset:27648
    s_mov_b64 exec, -1
    v_exp_f32 v34, v34
    v_exp_f32 v35, v35
    v_exp_f32 v36, v36
    v_exp_f32 v37, v37
    v_mfma_f32_32x32x16_bf16 v[48:63], v[12:15], v[8:11], v[112:127]
    ds_read_b128 v[12:15], v29 offset:27648
    v_exp_f32 v38, v38
    v_exp_f32 v39, v39
    v_exp_f32 v40, v40
    v_exp_f32 v41, v41
    v_exp_f32 v42, v42
    v_smfmac_f32_32x32x32_bf16 v[64:79], v[20:23], v[32:39], v28
    v_exp_f32 v43, v43
    v_exp_f32 v44, v44
    v_exp_f32 v45, v45
    v_exp_f32 v46, v46
    v_exp_f32 v47, v47
    v_exp_f32 v48, v48
    s_waitcnt lgkmcnt(0)
    v_exp_f32 v49, v49
    v_smfmac_f32_32x32x32_bf16 v[64:79], v[16:19], v[40:47], v28
    v_exp_f32 v50, v50
    v_exp_f32 v51, v51
    v_exp_f32 v52, v52
    v_mfma_f32_32x32x16_bf16 v[32:47], v[12:15], v[4:7], v[96:111]
    v_exp_f32 v53, v53
    v_exp_f32 v54, v54
    v_exp_f32 v55, v55
    v_exp_f32 v56, v56
    v_exp_f32 v57, v57
    v_exp_f32 v58, v58
    v_smfmac_f32_32x32x32_bf16 v[80:95], v[20:23], v[48:55], v28
    s_setprio 0
    v_exp_f32 v59, v59
    v_exp_f32 v60, v60
    v_exp_f32 v61, v61
    v_exp_f32 v62, v62
    s_setprio 1
    v_exp_f32 v63, v63
    v_exp_f32 v32, v32
    v_exp_f32 v33, v33
    v_smfmac_f32_32x32x32_bf16 v[80:95], v[16:19], v[56:63], v28
    s_mov_b64 exec, s[12:13]
    ds_read_b128 v[16:19], v30 offset:28160
    ds_read_b128 v[20:23], v30 offset:28672
    s_mov_b64 exec, -1
    v_exp_f32 v34, v34
    v_exp_f32 v35, v35
    v_exp_f32 v36, v36
    v_exp_f32 v37, v37
    v_mfma_f32_32x32x16_bf16 v[48:63], v[12:15], v[8:11], v[112:127]
    ds_read_b128 v[12:15], v29 offset:28672
    v_exp_f32 v38, v38
    v_exp_f32 v39, v39
    v_exp_f32 v40, v40
    v_exp_f32 v41, v41
    v_exp_f32 v42, v42
    v_smfmac_f32_32x32x32_bf16 v[64:79], v[24:27], v[32:39], v28
    v_exp_f32 v43, v43
    v_exp_f32 v44, v44
    v_exp_f32 v45, v45
    v_exp_f32 v46, v46
    v_exp_f32 v47, v47
    v_exp_f32 v48, v48
    s_waitcnt lgkmcnt(0)
    v_exp_f32 v49, v49
    v_smfmac_f32_32x32x32_bf16 v[64:79], v[16:19], v[40:47], v28
    v_exp_f32 v50, v50
    v_exp_f32 v51, v51
    v_exp_f32 v52, v52
    v_mfma_f32_32x32x16_bf16 v[32:47], v[12:15], v[4:7], v[96:111]
    v_exp_f32 v53, v53
    v_exp_f32 v54, v54
    v_exp_f32 v55, v55
    v_exp_f32 v56, v56
    v_exp_f32 v57, v57
    v_exp_f32 v58, v58
    v_smfmac_f32_32x32x32_bf16 v[80:95], v[24:27], v[48:55], v28
    s_setprio 0
    v_exp_f32 v59, v59
    v_exp_f32 v60, v60
    v_exp_f32 v61, v61
    v_exp_f32 v62, v62
    s_setprio 1
    v_exp_f32 v63, v63
    v_exp_f32 v32, v32
    v_exp_f32 v33, v33
    v_smfmac_f32_32x32x32_bf16 v[80:95], v[16:19], v[56:63], v28
    s_mov_b64 exec, s[12:13]
    ds_read_b128 v[16:19], v30 offset:29184
    ds_read_b128 v[24:27], v30 offset:29696
    s_mov_b64 exec, -1
    v_exp_f32 v34, v34
    v_exp_f32 v35, v35
    v_exp_f32 v36, v36
    v_exp_f32 v37, v37
    v_mfma_f32_32x32x16_bf16 v[48:63], v[12:15], v[8:11], v[112:127]
    ds_read_b128 v[12:15], v29 offset:29696
    v_exp_f32 v38, v38
    v_exp_f32 v39, v39
    v_exp_f32 v40, v40
    v_exp_f32 v41, v41
    v_exp_f32 v42, v42
    v_smfmac_f32_32x32x32_bf16 v[64:79], v[20:23], v[32:39], v28
    v_exp_f32 v43, v43
    v_exp_f32 v44, v44
    v_exp_f32 v45, v45
    v_exp_f32 v46, v46
    v_exp_f32 v47, v47
    v_exp_f32 v48, v48
    s_waitcnt lgkmcnt(0)
    v_exp_f32 v49, v49
    v_smfmac_f32_32x32x32_bf16 v[64:79], v[16:19], v[40:47], v28
    v_exp_f32 v50, v50
    v_exp_f32 v51, v51
    v_exp_f32 v52, v52
    v_mfma_f32_32x32x16_bf16 v[32:47], v[12:15], v[4:7], v[96:111]
    v_exp_f32 v53, v53
    v_exp_f32 v54, v54
    v_exp_f32 v55, v55
    v_exp_f32 v56, v56
    v_exp_f32 v57, v57
    v_exp_f32 v58, v58
    v_smfmac_f32_32x32x32_bf16 v[80:95], v[20:23], v[48:55], v28
    s_setprio 0
    v_exp_f32 v59, v59
    v_exp_f32 v60, v60
    v_exp_f32 v61, v61
    v_exp_f32 v62, v62
    s_setprio 1
    v_exp_f32 v63, v63
    v_exp_f32 v32, v32
    v_exp_f32 v33, v33
    v_smfmac_f32_32x32x32_bf16 v[80:95], v[16:19], v[56:63], v28
    s_mov_b64 exec, s[12:13]
    ds_read_b128 v[16:19], v30 offset:30208
    ds_read_b128 v[20:23], v30 offset:30720
    s_mov_b64 exec, -1
    v_exp_f32 v34, v34
    v_exp_f32 v35, v35
    v_exp_f32 v36, v36
    v_exp_f32 v37, v37
    v_mfma_f32_32x32x16_bf16 v[48:63], v[12:15], v[8:11], v[112:127]
    ds_read_b128 v[12:15], v29 offset:30720
    v_exp_f32 v38, v38
    v_exp_f32 v39, v39
    v_exp_f32 v40, v40
    v_exp_f32 v41, v41
    v_exp_f32 v42, v42
    v_smfmac_f32_32x32x32_bf16 v[64:79], v[24:27], v[32:39], v28
    v_exp_f32 v43, v43
    v_exp_f32 v44, v44
    v_exp_f32 v45, v45
    v_exp_f32 v46, v46
    v_exp_f32 v47, v47
    v_exp_f32 v48, v48
    s_waitcnt lgkmcnt(0)
    v_exp_f32 v49, v49
    v_smfmac_f32_32x32x32_bf16 v[64:79], v[16:19], v[40:47], v28
    v_exp_f32 v50, v50
    v_exp_f32 v51, v51
    v_exp_f32 v52, v52
    v_mfma_f32_32x32x16_bf16 v[32:47], v[12:15], v[4:7], v[96:111]
    v_exp_f32 v53, v53
    v_exp_f32 v54, v54
    v_exp_f32 v55, v55
    v_exp_f32 v56, v56
    v_exp_f32 v57, v57
    v_exp_f32 v58, v58
    v_smfmac_f32_32x32x32_bf16 v[80:95], v[24:27], v[48:55], v28
    s_setprio 0
    v_exp_f32 v59, v59
    v_exp_f32 v60, v60
    v_exp_f32 v61, v61
    v_exp_f32 v62, v62
    s_setprio 1
    v_exp_f32 v63, v63
    v_exp_f32 v32, v32
    v_exp_f32 v33, v33
    v_smfmac_f32_32x32x32_bf16 v[80:95], v[16:19], v[56:63], v28
    s_mov_b64 exec, s[12:13]
    ds_read_b128 v[16:19], v30 offset:31232
    ds_read_b128 v[24:27], v30 offset:31744
    s_mov_b64 exec, -1
    v_exp_f32 v34, v34
    v_exp_f32 v35, v35
    v_exp_f32 v36, v36
    v_exp_f32 v37, v37
    v_mfma_f32_32x32x16_bf16 v[48:63], v[12:15], v[8:11], v[112:127]
    ds_read_b128 v[12:15], v29 offset:31744
    v_exp_f32 v38, v38
    v_exp_f32 v39, v39
    v_exp_f32 v40, v40
    v_exp_f32 v41, v41
    v_exp_f32 v42, v42
    v_smfmac_f32_32x32x32_bf16 v[64:79], v[20:23], v[32:39], v28
    v_exp_f32 v43, v43
    v_exp_f32 v44, v44
    v_exp_f32 v45, v45
    v_exp_f32 v46, v46
    v_exp_f32 v47, v47
    v_exp_f32 v48, v48
    s_waitcnt lgkmcnt(0)
    v_exp_f32 v49, v49
    v_smfmac_f32_32x32x32_bf16 v[64:79], v[16:19], v[40:47], v28
    v_exp_f32 v50, v50
    v_exp_f32 v51, v51
    v_exp_f32 v52, v52
    v_mfma_f32_32x32x16_bf16 v[32:47], v[12:15], v[4:7], v[96:111]
    v_exp_f32 v53, v53
    v_exp_f32 v54, v54
    v_exp_f32 v55, v55
    v_exp_f32 v56, v56
    v_exp_f32 v57, v57
    v_exp_f32 v58, v58
    v_smfmac_f32_32x32x32_bf16 v[80:95], v[20:23], v[48:55], v28
    s_setprio 0
    v_exp_f32 v59, v59
    v_exp_f32 v60, v60
    v_exp_f32 v61, v61
    v_exp_f32 v62, v62
    s_setprio 1
    v_exp_f32 v63, v63
    v_exp_f32 v32, v32
    v_exp_f32 v33, v33
    v_smfmac_f32_32x32x32_bf16 v[80:95], v[16:19], v[56:63], v28
    s_mov_b64 exec, s[12:13]
    ds_read_b128 v[16:19], v30 offset:32256
    s_mov_b64 exec, -1
    ds_read_b32 v134, v31 offset:120
    v_exp_f32 v34, v34
    v_exp_f32 v35, v35
    v_exp_f32 v36, v36
    v_mfma_f32_32x32x16_bf16 v[48:63], v[12:15], v[8:11], v[112:127]
    v_exp_f32 v37, v37
    v_exp_f32 v38, v38
    v_exp_f32 v39, v39
    v_exp_f32 v40, v40
    v_exp_f32 v41, v41
    v_exp_f32 v42, v42
    v_smfmac_f32_32x32x32_bf16 v[64:79], v[24:27], v[32:39], v28
    v_exp_f32 v43, v43
    v_exp_f32 v44, v44
    v_exp_f32 v45, v45
    v_exp_f32 v46, v46
    v_exp_f32 v47, v47
    v_exp_f32 v48, v48
    s_waitcnt lgkmcnt(0)
    v_exp_f32 v49, v49
    v_smfmac_f32_32x32x32_bf16 v[64:79], v[16:19], v[40:47], v28
    v_exp_f32 v50, v50
    v_exp_f32 v51, v51
    v_exp_f32 v52, v52
    v_exp_f32 v53, v53
    v_exp_f32 v54, v54
    v_exp_f32 v55, v55
    v_exp_f32 v56, v56
    v_exp_f32 v57, v57
    v_exp_f32 v58, v58
    v_smfmac_f32_32x32x32_bf16 v[80:95], v[24:27], v[48:55], v28
    s_setprio 0
    v_exp_f32 v59, v59
    v_exp_f32 v60, v60
    v_exp_f32 v61, v61
    v_exp_f32 v62, v62
    s_setprio 1
    v_exp_f32 v63, v63
    s_mul_i32 s54, s3, 3072
    s_add_u32 s54, s54, 0
    v_smfmac_f32_32x32x32_bf16 v[80:95], v[16:19], v[56:63], v28
    v_add_u32 v128, s54, v1
    s_xor_b32 s54, s3, 4
    s_mul_i32 s54, s54, 3072
    s_add_u32 s54, s54, 0
    v_add_u32 v129, s54, v1
    s_add_u32 s20, s20, s21
    s_lshl_b32 s54, s20, 5
    s_add_u32 s54, s54, s22
    s_mul_i32 s55, s20, 4352
    s_lshl_b32 s56, s22, 7
    s_add_u32 s55, s55, s56
    s_add_u32 s55, s55, 13840640
    s_lshl_b32 s54, s54, 10
    s_add_u32 s54, s54, 6553600
    s_setprio 0
    v_readfirstlane_b32 s64, v134
    s_nop 0
    s_cmp_lt_u32 s64, 4
    s_cbranch_scc1 AS_46
AB_47:
    v_mov_b32 v73, v96
    ds_write_b128 v128, v[64:67]
    ds_write_b128 v128, v[68:71] offset:1024
    ds_write_b128 v128, v[72:75] offset:2048
    v_mov_b32 v64, v80
    v_mov_b32 v65, v81
    v_mov_b32 v66, v82
    v_mov_b32 v67, v83
    v_mov_b32 v68, v84
    v_mov_b32 v69, v85
    v_mov_b32 v70, v86
    v_mov_b32 v71, v87
    v_mov_b32 v72, v88
    v_mov_b32 v4, v8
    v_mov_b32 v5, v9
    v_mov_b32 v6, v10
    v_mov_b32 v7, v11
    v_mov_b32 v96, v112
L_ATT_X:
    s_waitcnt lgkmcnt(0)
    s_barrier
    ds_read_b128 v[40:43], v129 offset:2048
    ds_read_b128 v[32:35], v129
    ds_read_b128 v[36:39], v129 offset:1024
    s_mov_b32 s56, 0x5d800000
    s_waitcnt lgkmcnt(2)
    v_min_f32 v128, v96, v41
    v_sub_f32 v130, v128, v96
    v_sub_f32 v131, v128, v41
    v_exp_f32 v130, v130
    v_exp_f32 v131, v131
    v_cmp_nlt_f32 vcc, v72, s56
    v_cmp_nlt_f32 s[58:59], v40, s56
    v_mul_f32 v128, v72, v130
    v_fma_f32 v128, v40, v131, v128
    s_or_b32 s58, s58, vcc_lo
    v_mov_b32 v129, v128
    s_cmp_lg_u32 s58, 0
    s_cbranch_scc1 L_REDO
    v_permlane32_swap_b32 v128, v129
    v_rcp_f32 v128, v128
    s_waitcnt lgkmcnt(0)
    v_mul_f32 v130, v130, v128
    v_mul_f32 v131, v131, v128
    v_pk_mul_f32 v[64:65], v[64:65], v[130:131] op_sel:[0,0] op_sel_hi:[1,0]
    v_pk_mul_f32 v[66:67], v[66:67], v[130:131] op_sel:[0,0] op_sel_hi:[1,0]
    v_pk_mul_f32 v[68:69], v[68:69], v[130:131] op_sel:[0,0] op_sel_hi:[1,0]
    v_pk_mul_f32 v[70:71], v[70:71], v[130:131] op_sel:[0,0] op_sel_hi:[1,0]
    v_pk_fma_f32 v[64:65], v[32:33], v[130:131], v[64:65] op_sel:[0,1,0] op_sel_hi:[1,1,1]
    v_pk_fma_f32 v[66:67], v[34:35], v[130:131], v[66:67] op_sel:[0,1,0] op_sel_hi:[1,1,1]
    v_pk_fma_f32 v[68:69], v[36:37], v[130:131], v[68:69] op_sel:[0,1,0] op_sel_hi:[1,1,1]
    v_pk_fma_f32 v[70:71], v[38:39], v[130:131], v[70:71] op_sel:[0,1,0] op_sel_hi:[1,1,1]
L_FIN:
    v_cvt_pk_bf16_f32 v32, v64, v65
    v_cvt_pk_bf16_f32 v33, v66, v67
    v_cvt_pk_bf16_f32 v34, v68, v69
    v_cvt_pk_bf16_f32 v35, v70, v71
    buffer_store_dwordx4 v[32:35], v1, s[40:43], s54 offen sc1
    v_mov_b32 v128, 0
    v_mov_b32 v129, s50
    s_waitcnt vmcnt(0)
    s_mov_b64 exec, 1
    buffer_store_dword v129, v128, s[40:43], s55 offen sc1
    s_mov_b64 exec, -1
    s_endpgm
L_REDO:
    s_waitcnt lgkmcnt(0)
    v_mov_b32 v128, 0xff800000
    v_add_u32 v130, 32256, v1
    s_mov_b32 s57, 64
L_R1:
    ds_read_b128 v[12:15], v130
    v_add_u32 v130, 1024, v130
    s_waitcnt lgkmcnt(0)
    v_mfma_f32_32x32x16_bf16 v[32:47], v[12:15], v[4:7], 0
    s_nop 11
    v_max3_f32 v129, v32, v33, v34
    v_max3_f32 v129, v129, v35, v36
    v_max3_f32 v129, v129, v37, v38
    v_max3_f32 v129, v129, v39, v40
    v_max3_f32 v129, v129, v41, v42
    v_max3_f32 v129, v129, v43, v44
    v_max3_f32 v129, v129, v45, v46
    v_max_f32 v129, v129, v47
    v_max_f32 v128, v128, v129
    s_sub_u32 s57, s57, 1
    s_cmp_lg_u32 s57, 0
    s_cbranch_scc1 L_R1
    v_mov_b32 v129, v128
    s_nop 1
    v_permlane32_swap_b32 v128, v129
    v_max_f32 v128, v128, v129
    v_sub_f32 v96, 0, v128
    v_sub_f32 v97, 0, v128
    v_pk_mov_b32 v[98:99], v[96:97], v[96:97] op_sel:[0,1]
    v_pk_mov_b32 v[100:101], v[96:97], v[96:97] op_sel:[0,1]
    v_pk_mov_b32 v[102:103], v[96:97], v[96:97] op_sel:[0,1]
    v_pk_mov_b32 v[104:105], v[96:97], v[96:97] op_sel:[0,1]
    v_pk_mov_b32 v[106:107], v[96:97], v[96:97] op_sel:[0,1]
    v_pk_mov_b32 v[108:109], v[96:97], v[96:97] op_sel:[0,1]
    v_pk_mov_b32 v[110:111], v[96:97], v[96:97] op_sel:[0,1]
    v_mov_b32 v64, 0
    v_mov_b32 v65, 0
    v_mov_b32 v66, 0
    v_mov_b32 v67, 0
    v_mov_b32 v68, 0
    v_mov_b32 v69, 0
    v_mov_b32 v70, 0
    v_mov_b32 v71, 0
    v_mov_b32 v72, 0
    v_mov_b32 v73, 0
    v_mov_b32 v74, 0
    v_mov_b32 v75, 0
    v_mov_b32 v76, 0
    v_mov_b32 v77, 0
    v_mov_b32 v78, 0
    v_mov_b32 v79, 0
    v_add_u32 v130, 32256, v1
    s_lshl_b32 s57, s21, 15
    v_subrev_u32 v131, s57, v30
    s_mov_b32 s57, 64
L_R2:
    ds_read_b128 v[12:15], v130
    s_mov_b64 exec, s[12:13]
    ds_read_b128 v[20:23], v131
    ds_read_b128 v[16:19], v131 offset:512
    s_mov_b64 exec, -1
    v_add_u32 v130, 1024, v130
    v_add_u32 v131, 1024, v131
    s_waitcnt lgkmcnt(0)
    v_mfma_f32_32x32x16_bf16 v[32:47], v[12:15], v[4:7], v[96:111]
    s_nop 11
    v_exp_f32 v32, v32
    v_exp_f32 v33, v33
    v_exp_f32 v34, v34
    v_exp_f32 v35, v35
    v_exp_f32 v36, v36
    v_exp_f32 v37, v37
    v_exp_f32 v38, v38
    v_exp_f32 v39, v39
    v_exp_f32 v40, v40
    v_exp_f32 v41, v41
    v_exp_f32 v42, v42
    v_exp_f32 v43, v43
    v_exp_f32 v44, v44
    v_exp_f32 v45, v45
    v_exp_f32 v46, v46
    v_exp_f32 v47, v47
    v_smfmac_f32_32x32x32_bf16 v[64:79], v[20:23], v[32:39], v28
    s_nop 0
    v_smfmac_f32_32x32x32_bf16 v[64:79], v[16:19], v[40:47], v28
    s_sub_u32 s57, s57, 1
    s_cmp_lg_u32 s57, 0
    s_cbranch_scc1 L_R2
    s_nop 9
    v_mov_b32 v128, v72
    v_mov_b32 v129, v72
    s_nop 1
    v_permlane32_swap_b32 v128, v129
    v_rcp_f32 v128, v128
    s_nop 0
    v_mul_f32 v64, v64, v128
    v_mul_f32 v65, v65, v128
    v_mul_f32 v66, v66, v128
    v_mul_f32 v67, v67, v128
    v_mul_f32 v68, v68, v128
    v_mul_f32 v69, v69, v128
    v_mul_f32 v70, v70, v128
    v_mul_f32 v71, v71, v128
    s_branch L_FIN
AS_19:
    s_mov_b32 s65, 1048576
ASL_48:
    ds_read_b32 v134, v31 offset:120
    s_waitcnt lgkmcnt(0)
    s_sub_u32 s65, s65, 1
    s_cbranch_scc1 AB_20
    v_readfirstlane_b32 s64, v134
    s_nop 0
    s_cmp_ge_u32 s64, 4
    s_cbranch_scc1 AB_20
    s_sleep 1
    s_branch ASL_48
AS_46:
    s_mov_b32 s65, 1048576
ASL_49:
    ds_read_b32 v134, v31 offset:120
    s_waitcnt lgkmcnt(0)
    s_sub_u32 s65, s65, 1
    s_cbranch_scc1 AB_47
    v_readfirstlane_b32 s64, v134
    s_nop 0
    s_cmp_ge_u32 s64, 4
    s_cbranch_scc1 AB_47
    s_sleep 1
    s_branch ASL_49
L_AUX:
    s_setprio 2
    s_and_b32 s51, s3, 3
    v_lshrrev_b32 v5, 2, v0
    v_mul_u32_u24 v5, 3072, v5
    v_and_b32 v6, 3, v0
    v_lshl_add_u32 v5, v6, 4, v5
    s_lshl_b32 s54, s49, 6
    s_mul_i32 s55, s51, 49152
    s_add_u32 s54, s54, s55
    s_mul_i32 s55, s51, 3072
    s_add_u32 s55, s55, 32256
    s_lshl_b32 s56, s48, 2
    s_add_u32 s56, s56, s51
    s_lshl_b32 s56, s56, 15
    s_lshl_b32 s57, s51, 12
    s_add_u32 s57, s57, 44544
    s_mov_b32 s58, s10
    v_lshrrev_b32 v6, 4, v0
    v_and_b32 v7, 7, v0
    v_xor_b32 v6, v6, v7
    v_lshlrev_b32 v6, 4, v6
    v_lshrrev_b32 v7, 3, v0
    v_lshl_add_u32 v8, v7, 10, v6
    v_xor_b32 v9, 64, v8
    v_add_u32 v10, 14336, v8
    v_add_u32 v11, 21504, v9
    v_add_u32 v9, 7168, v9
    s_mov_b32 s36, s6
    s_and_b32 s37, s7, 0xffff
    s_mov_b32 s38, 0x180000
    s_mov_b32 s39, 0x20000
    v_mov_b32 v14, 0
    v_mov_b32 v15, 163360
    s_mov_b32 s50, 0
    s_lshl_b32 s59, s2, 4
    s_add_u32 s59, s59, s3
    s_cmp_lg_u32 s59, 8
    s_cbranch_scc1 L_TAG_MADE
    s_memrealtime s[60:61]
    s_waitcnt lgkmcnt(0)
    s_mul_i32 s60, s60, 0x9e3779b1
    s_or_b32 s60, s60, 1
    v_mov_b32 v7, s60
    s_mov_b64 exec, 1
    global_store_dword v14, v7, s[30:31] sc1
    s_mov_b64 exec, -1
L_TAG_MADE:
    s_mul_i32 s59, s58, 196608
    s_add_u32 s59, s59, s54
    s_add_u32 m0, s55, 0
    s_lshl_b32 s60, s58, 7
    buffer_load_dwordx4 v5, s[36:39], s59 offen offset:0 lds
    buffer_load_dwordx4 v5, s[36:39], s59 offen offset:1024 lds
    buffer_load_dwordx4 v5, s[36:39], s59 offen offset:2048 lds
    s_add_u32 m0, s57, 0
    s_add_u32 s60, s60, s56
    buffer_load_dwordx4 v8, s[32:35], s60 offen offset:0  lds
    buffer_load_dwordx4 v9, s[32:35], s60 offen offset:1024  lds
    buffer_load_dwordx4 v10, s[32:35], s60 offen offset:2048  lds
    buffer_load_dwordx4 v11, s[32:35], s60 offen offset:3072  lds
    s_add_u32 s58, s58, 1
    s_and_b32 s58, s58, 7
    s_lshl_b32 s59, s51, 2
    s_add_u32 s59, s59, 163328
    v_mov_b32 v12, s59
    v_mov_b32 v13, 163344
    v_mov_b32 v24, 1
    v_mov_b32 v25, 2
    v_mov_b32 v26, 3
    v_mov_b32 v27, 4
    v_mov_b32 v28, 5
    v_mov_b32 v29, 6
    v_mov_b32 v30, 7
    v_mov_b32 v31, 8
    s_lshr_b32 s59, s51, 1
    s_lshl_b32 s59, s59, 4
    v_lshrrev_b32 v6, 2, v0
    v_add_u32 v6, s59, v6
    v_and_b32 v7, 3, v0
    v_lshlrev_b32 v6, 12, v6
    v_lshl_add_u32 v32, v7, 4, v6
    s_lshl_b32 s59, s51, 11
    s_add_u32 s59, s59, 146944
    v_add_u32 v33, s59, v1
    v_mov_b32 v34, 163424
    s_lshl_b32 s7, s10, 1
    s_add_u32 s7, s7, s97
    s_and_b32 s7, s7, 15
    s_lshl_b32 s5, s7, 17
    s_lshl_b32 s6, s48, 6
    s_add_u32 s5, s5, s6
    s_and_b32 s6, s51, 1
    s_lshl_b32 s6, s6, 11
    s_add_u32 s5, s5, s6
    s_add_u32 s5, s5, 8716288
    s_mul_i32 s7, s7, 8448
    s_lshl_b32 s6, s48, 2
    s_add_u32 s6, s6, s51
    s_lshl_b32 s6, s6, 7
    s_add_u32 s7, s7, s6
    s_add_u32 s11, s7, 13631488
    global_load_dword v17, v14, s[30:31] sc1
    s_mul_i32 s59, s58, 196608
    s_add_u32 s59, s59, s54
    s_add_u32 m0, s55, 28672
    s_lshl_b32 s60, s58, 7
    buffer_load_dwordx4 v5, s[36:39], s59 offen offset:0 lds
    buffer_load_dwordx4 v5, s[36:39], s59 offen offset:1024 lds
    buffer_load_dwordx4 v5, s[36:39], s59 offen offset:2048 lds
    s_add_u32 m0, s57, 28672
    s_add_u32 s60, s60, s56
    buffer_load_dwordx4 v8, s[32:35], s60 offen offset:0  lds
    buffer_load_dwordx4 v9, s[32:35], s60 offen offset:1024  lds
    buffer_load_dwordx4 v10, s[32:35], s60 offen offset:2048  lds
    buffer_load_dwordx4 v11, s[32:35], s60 offen offset:3072  lds
    s_add_u32 s58, s58, 1
    s_and_b32 s58, s58, 7
    s_waitcnt vmcnt(8)
    ds_write_b32 v12, v24
    global_load_dword v18, v14, s[30:31] sc1
    s_mul_i32 s59, s58, 196608
    s_add_u32 s59, s59, s54
    s_add_u32 m0, s55, 57344
    s_lshl_b32 s60, s58, 7
    buffer_load_dwordx4 v5, s[36:39], s59 offen offset:0 lds
    buffer_load_dwordx4 v5, s[36:39], s59 offen offset:1024 lds
    buffer_load_dwordx4 v5, s[36:39], s59 offen offset:2048 lds
    s_add_u32 m0, s57, 57344
    s_add_u32 s60, s60, s56
    buffer_load_dwordx4 v8, s[32:35], s60 offen offset:0  lds
    buffer_load_dwordx4 v9, s[32:35], s60 offen offset:1024  lds
    buffer_load_dwordx4 v10, s[32:35], s60 offen offset:2048  lds
    buffer_load_dwordx4 v11, s[32:35], s60 offen offset:3072  lds
    s_add_u32 s58, s58, 1
    s_and_b32 s58, s58, 7
    s_waitcnt vmcnt(8)
    ds_write_b32 v12, v25
    s_mov_b64 exec, 1
    ds_or_b32 v15, v17
    s_mov_b64 exec, -1
    s_mul_i32 s59, s58, 196608
    s_add_u32 s59, s59, s54
    s_add_u32 m0, s55, 86016
    s_lshl_b32 s60, s58, 7
    buffer_load_dwordx4 v5, s[36:39], s59 offen offset:0 lds
    buffer_load_dwordx4 v5, s[36:39], s59 offen offset:1024 lds
    buffer_load_dwordx4 v5, s[36:39], s59 offen offset:2048 lds
    s_add_u32 m0, s57, 86016
    s_add_u32 s60, s60, s56
    buffer_load_dwordx4 v8, s[32:35], s60 offen offset:0  lds
    buffer_load_dwordx4 v9, s[32:35], s60 offen offset:1024  lds
    buffer_load_dwordx4 v10, s[32:35], s60 offen offset:2048  lds
    buffer_load_dwordx4 v11, s[32:35], s60 offen offset:3072  lds
    s_add_u32 s58, s58, 1
    s_and_b32 s58, s58, 7
    s_mov_b32 s65, 1048576
MW_50:
    ds_read_b128 v[60:63], v34
    s_waitcnt lgkmcnt(0)
MWC_52:
    v_min3_u32 v60, v60, v61, v62
    v_min_u32 v60, v60, v63
    s_sub_u32 s65, s65, 1
    s_cbranch_scc1 MWD_51
    v_readfirstlane_b32 s64, v60
    s_nop 0
    s_cmp_ge_u32 s64, 1
    s_cbranch_scc1 MWD_51
    s_sleep 1
    s_branch MW_50
MWD_51:
    ds_read_b128 v[36:39], v33
    ds_read_b128 v[40:43], v33 offset:1024
    s_waitcnt lgkmcnt(0)
    buffer_store_dwordx4 v[36:39], v32, s[40:43], s5 offen sc1
    buffer_store_dwordx4 v[40:43], v32, s[40:43], s5 offen offset:1024 sc1
    s_waitcnt vmcnt(9)
    ds_write_b32 v12, v26
    s_mov_b64 exec, 1
    ds_or_b32 v15, v18
    s_mov_b64 exec, -1
    ds_read_b128 v[60:63], v13
    s_waitcnt lgkmcnt(0)
    v_min3_u32 v60, v60, v61, v62
    v_min_u32 v60, v60, v63
    s_nop 0
    v_readfirstlane_b32 s64, v60
    s_nop 0
    s_cmp_ge_u32 s64, 1
    s_cbranch_scc1 FR_53
    s_waitcnt vmcnt(2)
    ds_write_b32 v12, v27
    s_mov_b32 s65, 1048576
MW_54:
    ds_read_b128 v[60:63], v13
    s_waitcnt lgkmcnt(0)
MWC_56:
    v_min3_u32 v60, v60, v61, v62
    v_min_u32 v60, v60, v63
    s_sub_u32 s65, s65, 1
    s_cbranch_scc1 MWD_55
    v_readfirstlane_b32 s64, v60
    s_nop 0
    s_cmp_ge_u32 s64, 1
    s_cbranch_scc1 MWD_55
    s_sleep 1
    s_branch MW_54
MWD_55:
FR_53:
    global_load_dword v20, v14, s[30:31] sc1
    s_mul_i32 s59, s58, 196608
    s_add_u32 s59, s59, s54
    s_add_u32 m0, s55, 0
    s_lshl_b32 s60, s58, 7
    buffer_load_dwordx4 v5, s[36:39], s59 offen offset:0 lds
    buffer_load_dwordx4 v5, s[36:39], s59 offen offset:1024 lds
    buffer_load_dwordx4 v5, s[36:39], s59 offen offset:2048 lds
    s_add_u32 m0, s57, 0
    s_add_u32 s60, s60, s56
    buffer_load_dwordx4 v8, s[32:35], s60 offen offset:0  lds
    buffer_load_dwordx4 v9, s[32:35], s60 offen offset:1024  lds
    buffer_load_dwordx4 v10, s[32:35], s60 offen offset:2048  lds
    buffer_load_dwordx4 v11, s[32:35], s60 offen offset:3072  lds
    s_add_u32 s58, s58, 1
    s_and_b32 s58, s58, 7
    s_waitcnt vmcnt(10)
    ds_write_b32 v12, v27
    ds_read_b128 v[60:63], v13
    s_waitcnt lgkmcnt(0)
    v_min3_u32 v60, v60, v61, v62
    v_min_u32 v60, v60, v63
    s_nop 0
    v_readfirstlane_b32 s64, v60
    s_nop 0
    s_cmp_ge_u32 s64, 2
    s_cbranch_scc1 FR_57
    s_waitcnt vmcnt(0)
    ds_write_b32 v12, v28
    s_mov_b32 s65, 1048576
MW_58:
    ds_read_b128 v[60:63], v13
    s_waitcnt lgkmcnt(0)
MWC_60:
    v_min3_u32 v60, v60, v61, v62
    v_min_u32 v60, v60, v63
    s_sub_u32 s65, s65, 1
    s_cbranch_scc1 MWD_59
    v_readfirstlane_b32 s64, v60
    s_nop 0
    s_cmp_ge_u32 s64, 2
    s_cbranch_scc1 MWD_59
    s_sleep 1
    s_branch MW_58
MWD_59:
FR_57:
    s_mul_i32 s59, s58, 196608
    s_add_u32 s59, s59, s54
    s_add_u32 m0, s55, 28672
    s_lshl_b32 s60, s58, 7
    buffer_load_dwordx4 v5, s[36:39], s59 offen offset:0 lds
    buffer_load_dwordx4 v5, s[36:39], s59 offen offset:1024 lds
    buffer_load_dwordx4 v5, s[36:39], s59 offen offset:2048 lds
    s_add_u32 m0, s57, 28672
    s_add_u32 s60, s60, s56
    buffer_load_dwordx4 v8, s[32:35], s60 offen offset:0  lds
    buffer_load_dwordx4 v9, s[32:35], s60 offen offset:1024  lds
    buffer_load_dwordx4 v10, s[32:35], s60 offen offset:2048  lds
    buffer_load_dwordx4 v11, s[32:35], s60 offen offset:3072  lds
    s_add_u32 s58, s58, 1
    s_and_b32 s58, s58, 7
    s_waitcnt vmcnt(7)
    ds_write_b32 v12, v28
    s_mov_b64 exec, 1
    ds_or_b32 v15, v20
    s_mov_b64 exec, -1
    ds_read_b32 v35, v15
    s_waitcnt lgkmcnt(0)
    s_mov_b64 exec, 1
    buffer_store_dword v35, v14, s[40:43], s11 offen sc1
    s_mov_b64 exec, -1
    ds_read_b128 v[60:63], v13
    s_waitcnt lgkmcnt(0)
    v_min3_u32 v60, v60, v61, v62
    v_min_u32 v60, v60, v63
    s_nop 0
    v_readfirstlane_b32 s64, v60
    s_nop 0
    s_cmp_ge_u32 s64, 3
    s_cbranch_scc1 FR_61
    s_waitcnt vmcnt(1)
    ds_write_b32 v12, v29
    s_mov_b32 s65, 1048576
MW_62:
    ds_read_b128 v[60:63], v13
    s_waitcnt lgkmcnt(0)
MWC_64:
    v_min3_u32 v60, v60, v61, v62
    v_min_u32 v60, v60, v63
    s_sub_u32 s65, s65, 1
    s_cbranch_scc1 MWD_63
    v_readfirstlane_b32 s64, v60
    s_nop 0
    s_cmp_ge_u32 s64, 3
    s_cbranch_scc1 MWD_63
    s_sleep 1
    s_branch MW_62
MWD_63:
FR_61:
    s_mul_i32 s59, s58, 196608
    s_add_u32 s59, s59, s54
    s_add_u32 m0, s55, 57344
    s_lshl_b32 s60, s58, 7
    buffer_load_dwordx4 v5, s[36:39], s59 offen offset:0 lds
    buffer_load_dwordx4 v5, s[36:39], s59 offen offset:1024 lds
    buffer_load_dwordx4 v5, s[36:39], s59 offen offset:2048 lds
    s_add_u32 m0, s57, 57344
    s_add_u32 s60, s60, s56
    buffer_load_dwordx4 v8, s[32:35], s60 offen offset:0  lds
    buffer_load_dwordx4 v9, s[32:35], s60 offen offset:1024  lds
    buffer_load_dwordx4 v10, s[32:35], s60 offen offset:2048  lds
    buffer_load_dwordx4 v11, s[32:35], s60 offen offset:3072  lds
    s_add_u32 s58, s58, 1
    s_and_b32 s58, s58, 7
    s_waitcnt vmcnt(8)
    ds_write_b32 v12, v29
    ds_read_b128 v[60:63], v13
    s_waitcnt lgkmcnt(0)
    v_min3_u32 v60, v60, v61, v62
    v_min_u32 v60, v60, v63
    s_nop 0
    v_readfirstlane_b32 s64, v60
    s_nop 0
    s_cmp_ge_u32 s64, 4
    s_cbranch_scc1 FR_65
    s_waitcnt vmcnt(0)
    ds_write_b32 v12, v30
    s_mov_b32 s65, 1048576
MW_66:
    ds_read_b128 v[60:63], v13
    s_waitcnt lgkmcnt(0)
MWC_68:
    v_min3_u32 v60, v60, v61, v62
    v_min_u32 v60, v60, v63
    s_sub_u32 s65, s65, 1
    s_cbranch_scc1 MWD_67
    v_readfirstlane_b32 s64, v60
    s_nop 0
    s_cmp_ge_u32 s64, 4
    s_cbranch_scc1 MWD_67
    s_sleep 1
    s_branch MW_66
MWD_67:
FR_65:
    s_mul_i32 s59, s58, 196608
    s_add_u32 s59, s59, s54
    s_add_u32 m0, s55, 86016
    s_lshl_b32 s60, s58, 7
    buffer_load_dwordx4 v5, s[36:39], s59 offen offset:0 lds
    buffer_load_dwordx4 v5, s[36:39], s59 offen offset:1024 lds
    buffer_load_dwordx4 v5, s[36:39], s59 offen offset:2048 lds
    s_add_u32 m0, s57, 86016
    s_add_u32 s60, s60, s56
    buffer_load_dwordx4 v8, s[32:35], s60 offen offset:0  lds
    buffer_load_dwordx4 v9, s[32:35], s60 offen offset:1024  lds
    buffer_load_dwordx4 v10, s[32:35], s60 offen offset:2048  lds
    buffer_load_dwordx4 v11, s[32:35], s60 offen offset:3072  lds
    s_add_u32 s58, s58, 1
    s_and_b32 s58, s58, 7
    s_waitcnt vmcnt(7)
    ds_write_b32 v12, v30
    s_waitcnt vmcnt(0)
    ds_write_b32 v12, v31
    s_setprio 3
    ds_read_b32 v16, v15
    s_mov_b32 s65, 131072
    s_waitcnt lgkmcnt(0)
    v_readfirstlane_b32 s50, v16
L_TAG_P:
    s_nop 0
    s_cmp_lg_u32 s50, 0
    s_cbranch_scc1 L_TAG_OK
    global_load_dword v16, v14, s[30:31] sc1
    s_waitcnt vmcnt(0)
    v_readfirstlane_b32 s50, v16
    s_sub_u32 s65, s65, 1
    s_cbranch_scc0 L_TAG_P
    s_mov_b32 s50, 1
L_TAG_OK:
    v_mov_b32 v16, s50
    ds_write_b32 v15, v16
    v_readfirstlane_b32 s59, v35
    s_nop 0
    s_cmp_lg_u32 s59, 0
    s_cbranch_scc1 L_XF_OK
    s_mov_b64 exec, 1
    buffer_store_dword v16, v14, s[40:43], s11 offen sc1
    s_mov_b64 exec, -1
L_XF_OK:
    s_and_b32 s60, s2, 7
    s_lshl_b32 s60, s60, 5
    s_lshr_b32 s61, s2, 3
    s_add_u32 s60, s60, s61
    s_lshr_b32 s57, s60, 4
    s_mul_i32 s57, s57, 8448
    s_add_u32 s57, s57, 13631488
    s_lshl_b32 s60, s60, 13
    s_lshl_b32 s61, s51, 11
    s_add_u32 s60, s60, s61
    s_add_u32 s60, s60, 8716288
    s_lshr_b32 s61, s51, 1
    s_mul_i32 s61, s61, 16128
    s_and_b32 s62, s51, 1
    s_mul_i32 s62, s62, 3072
    s_add_u32 s61, s61, s62
    v_and_b32 v5, 63, v0
    v_lshlrev_b32 v5, 7, v5
    s_cmp_lg_u32 s3, 8
    s_cbranch_scc1 L_U_SKIP
    v_mov_b32 v6, 163400
    s_mov_b32 s65, 1048576
LW_69:
    ds_read_b32 v7, v6
    s_waitcnt lgkmcnt(0)
    v_readfirstlane_b32 s64, v7
    s_sub_u32 s65, s65, 1
    s_cbranch_scc1 LWD_70
    s_cmp_lt_u32 s64, 2
    s_cbranch_scc0 LWD_70
    s_sleep 1
    s_branch LW_69
LWD_70:
    s_mov_b32 s65, 131072
    buffer_load_dword v18, v5, s[40:43], s57 offen sc1
FF_71:
    s_sleep 2
    buffer_load_dword v19, v5, s[40:43], s57 offen sc1
    s_waitcnt vmcnt(1)
    v_cmp_ne_u32 vcc, s50, v18
    s_sub_u32 s65, s65, 1
    s_cbranch_scc1 FFD_72
    s_cmp_eq_u64 vcc, 0
    s_cbranch_scc1 FFD_72
    s_sleep 2
    buffer_load_dword v18, v5, s[40:43], s57 offen sc1
    s_waitcnt vmcnt(1)
    v_cmp_ne_u32 vcc, s50, v19
    s_sub_u32 s65, s65, 1
    s_cbranch_scc1 FFD_72
    s_cmp_eq_u64 vcc, 0
    s_cbranch_scc1 FFD_72
    s_branch FF_71
FFD_72:
    s_mov_b32 m0, 8832
    s_nop 0
    buffer_load_dwordx4 v1, s[40:43], s60 offen offset:0 sc1 lds
    s_mov_b32 m0, 9344
    s_nop 0
    buffer_load_dwordx4 v1, s[40:43], s60 offen offset:1024 sc1 lds
    s_mov_b32 m0, 9856
    s_nop 0
    buffer_load_dwordx4 v1, s[40:43], s60 offen offset:2048 sc1 lds
    s_mov_b32 m0, 10368
    s_nop 0
    buffer_load_dwordx4 v1, s[40:43], s60 offen offset:3072 sc1 lds
    s_add_u32 s60, s60, 4096
    s_mov_b32 m0, 24960
    s_nop 0
    buffer_load_dwordx4 v1, s[40:43], s60 offen offset:0 sc1 lds
    s_mov_b32 m0, 25472
    s_nop 0
    buffer_load_dwordx4 v1, s[40:43], s60 offen offset:1024 sc1 lds
    s_mov_b32 m0, 25984
    s_nop 0
    buffer_load_dwordx4 v1, s[40:43], s60 offen offset:2048 sc1 lds
    s_mov_b32 m0, 26496
    s_nop 0
    buffer_load_dwordx4 v1, s[40:43], s60 offen offset:3072 sc1 lds
L_U_SKIP:
    s_setprio 0
    v_and_b32 v6, 1, v2
    v_lshlrev_b32 v6, 4, v6
    v_mov_b32 v7, 0x3f80
    v_lshlrev_b32 v6, v6, v7
    v_lshrrev_b32 v7, 1, v2
    v_lshlrev_b32 v8, 2, v3
    v_sub_u32 v7, v7, v8
    v_cmp_eq_u32 s[12:13], 0, v7
    v_cmp_eq_u32 s[14:15], 1, v7
    v_cmp_eq_u32 s[16:17], 2, v7
    v_cmp_eq_u32 s[18:19], 3, v7
    v_cndmask_b32 v8, 0, v6, s[12:13]
    v_cndmask_b32 v9, 0, v6, s[14:15]
    v_cndmask_b32 v10, 0, v6, s[16:17]
    v_cndmask_b32 v11, 0, v6, s[18:19]
    v_cmp_eq_u32 s[12:13], 8, v7
    v_cmp_eq_u32 s[14:15], 9, v7
    v_cmp_eq_u32 s[16:17], 10, v7
    v_cmp_eq_u32 s[18:19], 11, v7
    v_cndmask_b32 v12, 0, v6, s[12:13]
    v_cndmask_b32 v13, 0, v6, s[14:15]
    v_cndmask_b32 v14, 0, v6, s[16:17]
    v_cndmask_b32 v15, 0, v6, s[18:19]
    s_waitcnt vmcnt(0)
    v_mov_b32 v6, 163404
    v_mov_b32 v7, 1
    s_mov_b64 exec, 1
    ds_add_u32 v6, v7
    s_mov_b64 exec, -1
    s_and_b32 s56, s2, 31
    s_lshr_b32 s57, s56, 1
    s_mul_i32 s57, s57, 4352
    s_add_u32 s57, s57, 13766656
    s_lshl_b32 s56, s56, 16
    s_lshr_b32 s58, s51, 1
    s_lshl_b32 s58, s58, 15
    s_and_b32 s59, s51, 1
    s_lshl_b32 s55, s59, 16
    s_add_u32 s55, s55, s58
    s_add_u32 s55, s55, 32256
    s_mul_i32 s54, s59, 2162688
    s_add_u32 s54, s54, s58
    s_add_u32 s54, s54, s56
    s_add_u32 s54, s54, 2228224
    s_lshr_b32 s58, s2, 5
    s_lshl_b32 s58, s58, 2
    s_add_u32 s58, s58, s51
    s_lshl_b32 s58, s58, 11
    s_add_u32 s56, s56, s58
    s_add_u32 s56, s56, 65536
    v_mov_b32 v6, 163364
    v_and_b32 v5, 15, v0
    v_lshlrev_b32 v5, 7, v5
    s_mov_b32 s65, 1048576
LW_73:
    ds_read_b32 v7, v6
    s_waitcnt lgkmcnt(0)
    v_readfirstlane_b32 s64, v7
    s_sub_u32 s65, s65, 1
    s_cbranch_scc1 LWD_74
    s_cmp_lt_u32 s64, 8
    s_cbranch_scc0 LWD_74
    s_sleep 1
    s_branch LW_73
LWD_74:
    v_mov_b32 v16, 163396
    s_mov_b32 s65, 1048576
LW_75:
    ds_read_b32 v7, v16
    s_waitcnt lgkmcnt(0)
    v_readfirstlane_b32 s64, v7
    s_sub_u32 s65, s65, 1
    s_cbranch_scc1 LWD_76
    s_cmp_lt_u32 s64, 4
    s_cbranch_scc0 LWD_76
    s_sleep 1
    s_branch LW_75
LWD_76:
    s_mov_b32 s65, 131072
FW_77:
    buffer_load_dword v7, v5, s[40:43], s57 offen sc1
    s_waitcnt vmcnt(0)
    v_xor_b32 v7, s50, v7
    v_cmp_ne_u32 vcc, 0, v7
    s_sub_u32 s65, s65, 1
    s_cbranch_scc1 FWD_78
    s_cmp_eq_u64 vcc, 0
    s_cbranch_scc1 FWD_78
    s_sleep 1
    s_branch FW_77
FWD_78:
    s_lshl_b32 s58, s51, 11
    s_add_u32 m0, s58, 155136
    s_nop 0
    buffer_load_dwordx4 v1, s[40:43], s56 offen offset:0 sc1 lds
    buffer_load_dwordx4 v1, s[40:43], s56 offen offset:1024 sc1 lds
    s_add_u32 m0, s55, 0
    s_add_u32 s58, s54, 0
    buffer_load_dwordx4 v1, s[40:43], s58 offen offset:0 sc1 lds
    buffer_load_dwordx4 v1, s[40:43], s58 offen offset:1024 sc1 lds
    buffer_load_dwordx4 v1, s[40:43], s58 offen offset:2048 sc1 lds
    buffer_load_dwordx4 v1, s[40:43], s58 offen offset:3072 sc1 lds
    s_add_u32 m0, s55, 4096
    s_add_u32 s58, s54, 4096
    buffer_load_dwordx4 v1, s[40:43], s58 offen offset:0 sc1 lds
    buffer_load_dwordx4 v1, s[40:43], s58 offen offset:1024 sc1 lds
    buffer_load_dwordx4 v1, s[40:43], s58 offen offset:2048 sc1 lds
    buffer_load_dwordx4 v1, s[40:43], s58 offen offset:3072 sc1 lds
    s_waitcnt vmcnt(6)
    s_setprio 3
    s_barrier
    s_add_u32 m0, s55, 8192
    s_add_u32 s58, s54, 8192
    buffer_load_dwordx4 v1, s[40:43], s58 offen offset:0 sc1 lds
    buffer_load_dwordx4 v1, s[40:43], s58 offen offset:1024 sc1 lds
    buffer_load_dwordx4 v1, s[40:43], s58 offen offset:2048 sc1 lds
    buffer_load_dwordx4 v1, s[40:43], s58 offen offset:3072 sc1 lds
    s_add_u32 m0, s55, 12288
    s_add_u32 s58, s54, 12288
    buffer_load_dwordx4 v1, s[40:43], s58 offen offset:0 sc1 lds
    buffer_load_dwordx4 v1, s[40:43], s58 offen offset:1024 sc1 lds
    buffer_load_dwordx4 v1, s[40:43], s58 offen offset:2048 sc1 lds
    buffer_load_dwordx4 v1, s[40:43], s58 offen offset:3072 sc1 lds
    s_add_u32 m0, s55, 16384
    s_add_u32 s58, s54, 16384
    buffer_load_dwordx4 v1, s[40:43], s58 offen offset:0 sc1 lds
    buffer_load_dwordx4 v1, s[40:43], s58 offen offset:1024 sc1 lds
    buffer_load_dwordx4 v1, s[40:43], s58 offen offset:2048 sc1 lds
    buffer_load_dwordx4 v1, s[40:43], s58 offen offset:3072 sc1 lds
    s_waitcnt vmcnt(12)
    s_barrier
    s_cmp_lg_u32 s3, 11
    s_cbranch_scc1 L_NOWO1
    s_lshr_b32 s60, s2, 4
    s_lshl_b32 s60, s60, 15
    s_and_b32 s61, s2, 15
    s_lshl_b32 s61, s61, 6
    s_add_u32 s60, s60, s61
    v_lshlrev_b32 v6, 10, v2
    v_lshl_add_u32 v6, v3, 4, v6
    v_add_u32 v6, s60, v6
    global_load_dwordx4 v[158:161], v6, s[8:9]
    global_load_dwordx4 v[162:165], v6, s[8:9] offset:32
L_NOWO1:
    s_lshl_b32 s4, s48, 7
    s_lshl_b32 s60, s49, 3
    s_add_u32 s4, s4, s60
    s_and_b32 s60, s3, 3
    s_lshl_b32 s60, s60, 1
    s_add_u32 s4, s4, s60
    s_lshl_b32 s60, s4, 10
    buffer_load_dwordx4 v[146:149], v1, s[32:35], s60 offen
    buffer_load_dwordx4 v[150:153], v1, s[32:35], s60 offen offset:1024
    global_load_dwordx4 v[154:157], v1, s[24:25]
    s_add_u32 m0, s55, 20480
    s_add_u32 s58, s54, 20480
    buffer_load_dwordx4 v1, s[40:43], s58 offen offset:0 sc1 lds
    buffer_load_dwordx4 v1, s[40:43], s58 offen offset:1024 sc1 lds
    buffer_load_dwordx4 v1, s[40:43], s58 offen offset:2048 sc1 lds
    buffer_load_dwordx4 v1, s[40:43], s58 offen offset:3072 sc1 lds
    s_add_u32 m0, s55, 24576
    s_add_u32 s58, s54, 24576
    buffer_load_dwordx4 v1, s[40:43], s58 offen offset:0 sc1 lds
    buffer_load_dwordx4 v1, s[40:43], s58 offen offset:1024 sc1 lds
    buffer_load_dwordx4 v1, s[40:43], s58 offen offset:2048 sc1 lds
    buffer_load_dwordx4 v1, s[40:43], s58 offen offset:3072 sc1 lds
    s_add_u32 m0, s55, 28672
    s_add_u32 s58, s54, 28672
    buffer_load_dwordx4 v1, s[40:43], s58 offen offset:0 sc1 lds
    buffer_load_dwordx4 v1, s[40:43], s58 offen offset:1024 sc1 lds
    buffer_load_dwordx4 v1, s[40:43], s58 offen offset:2048 sc1 lds
    buffer_load_dwordx4 v1, s[40:43], s58 offen offset:3072 sc1 lds
    v_mov_b32 v144, 0
    v_mov_b32 v145, 0
    s_waitcnt vmcnt(12)
    v_dot2_f32_bf16 v144, v146, v154, v144
    v_dot2_f32_bf16 v145, v150, v154, v145
    v_dot2_f32_bf16 v144, v147, v155, v144
    v_dot2_f32_bf16 v145, v151, v155, v145
    v_dot2_f32_bf16 v144, v148, v156, v144
    v_dot2_f32_bf16 v145, v152, v156, v145
    v_dot2_f32_bf16 v144, v149, v157, v144
    v_dot2_f32_bf16 v145, v153, v157, v145
    s_nop 2
    v_add_f32_dpp v144, v144, v144 row_shr:1
    v_add_f32_dpp v145, v145, v145 row_shr:1
    s_nop 0
    v_add_f32_dpp v144, v144, v144 row_shr:2
    v_add_f32_dpp v145, v145, v145 row_shr:2
    s_nop 0
    v_add_f32_dpp v144, v144, v144 row_shr:4
    v_add_f32_dpp v145, v145, v145 row_shr:4
    s_nop 0
    v_add_f32_dpp v144, v144, v144 row_shr:8
    v_add_f32_dpp v145, v145, v145 row_shr:8
    s_nop 0
    v_add_f32_dpp v144, v144, v144 row_bcast:15 row_mask:0xa
    v_add_f32_dpp v145, v145, v145 row_bcast:15 row_mask:0xa
    s_nop 0
    v_add_f32_dpp v144, v144, v144 row_bcast:31 row_mask:0xc
    v_add_f32_dpp v145, v145, v145 row_bcast:31 row_mask:0xc
    v_mul_f32 v144, 0xbfb8aa3b, v144
    v_mul_f32 v145, 0xbfb8aa3b, v145
    v_exp_f32 v144, v144
    v_exp_f32 v145, v145
    v_add_f32 v144, 1.0, v144
    v_add_f32 v145, 1.0, v145
    v_rcp_f32 v144, v144
    v_rcp_f32 v145, v145
    s_lshl_b32 s4, s4, 2
    s_add_u32 s4, s4, 13565952
    v_mov_b32 v146, 0
    s_mov_b32 exec_lo, 0
    s_brev_b32 exec_hi, 1
    buffer_store_dwordx2 v[144:145], v146, s[40:43], s4 offen sc1
    s_mov_b64 exec, -1
    s_cmp_lg_u32 s3, 11
    s_cbranch_scc1 L_NOWO2
    v_mfma_f32_32x32x16_bf16 v[112:127], v[158:161], v[8:11], 0
    v_mfma_f32_32x32x16_bf16 v[112:127], v[162:165], v[12:15], v[112:127]
    v_lshl_add_u32 v6, v3, 5, v4
    v_lshlrev_b32 v6, 4, v6
    s_and_b32 s60, s2, 15
    s_lshl_b32 s60, s60, 15
    s_lshr_b32 s61, s2, 4
    s_lshl_b32 s61, s61, 11
    s_add_u32 s60, s60, s61
    s_add_u32 s60, s60, 13041664
    s_nop 3
    v_cvt_pk_bf16_f32 v158, v112, v113
    v_cvt_pk_bf16_f32 v159, v114, v115
    v_cvt_pk_bf16_f32 v160, v116, v117
    v_cvt_pk_bf16_f32 v161, v118, v119
    v_cvt_pk_bf16_f32 v162, v120, v121
    v_cvt_pk_bf16_f32 v163, v122, v123
    v_cvt_pk_bf16_f32 v164, v124, v125
    v_cvt_pk_bf16_f32 v165, v126, v127
    buffer_store_dwordx4 v[158:161], v6, s[40:43], s60 offen sc1
    buffer_store_dwordx4 v[162:165], v6, s[40:43], s60 offen offset:1024 sc1
L_NOWO2:
    s_waitcnt vmcnt(1)
    s_barrier
    s_lshl_b32 s60, s51, 12
    s_add_u32 s60, s60, 16384
    v_add_u32 v6, s60, v1
    ds_read_b128 v[16:19], v6
    ds_read_b128 v[20:23], v6 offset:1024
    s_and_b32 s60, s2, 7
    s_lshl_b32 s60, s60, 5
    s_lshr_b32 s61, s2, 3
    s_add_u32 s60, s60, s61
    s_lshl_b32 s60, s60, 13
    s_lshl_b32 s61, s51, 11
    s_add_u32 s60, s60, s61
    s_add_u32 s60, s60, 10878976
    s_waitcnt lgkmcnt(0)
    buffer_store_dwordx4 v[16:19], v1, s[40:43], s60 offen sc1
    buffer_store_dwordx4 v[20:23], v1, s[40:43], s60 offen offset:1024 sc1
    v_mov_b32 v6, 163448
    v_mov_b32 v7, 1
    s_mov_b64 exec, 1
    ds_add_u32 v6, v7
    s_mov_b64 exec, -1
    s_lshl_b32 s4, s2, 2
    s_add_u32 s4, s4, 13836288
    v_mov_b32 v6, 163420
    v_mov_b32 v7, 1
    s_waitcnt vmcnt(0)
    s_mov_b64 exec, 1
    ds_add_rtn_u32 v7, v6, v7
    s_waitcnt lgkmcnt(0)
    v_readfirstlane_b32 s64, v7
    v_mov_b32 v6, 0
    v_mov_b32 v7, s50
    s_cmp_lg_u32 s64, 3
    s_cbranch_scc1 GF_79
    buffer_store_dword v7, v6, s[40:43], s4 offen sc1
GF_79:
    s_mov_b64 exec, -1
    s_setprio 3
    s_setprio 3
    s_and_b32 s52, s2, 7
    s_lshl_b32 s52, s52, 3
    s_bfe_u32 s54, s2, 0x30003
    s_add_u32 s52, s52, s54
    s_lshr_b32 s53, s2, 6
    s_mov_b32 s54, 13836288
    v_mov_b32 v6, 163416
    s_cmp_lg_u32 s3, 8
    s_cbranch_scc1 RL_80
    s_mov_b32 s65, 131072
FW_82:
    buffer_load_dwordx4 v[16:19], v1, s[40:43], s54 offen offset:0 sc1
    s_waitcnt vmcnt(0)
    v_xor_b32 v16, s50, v16
    v_xor_b32 v17, s50, v17
    v_xor_b32 v18, s50, v18
    v_xor_b32 v19, s50, v19
    v_or_b32 v16, v16, v17
    v_or_b32 v16, v16, v18
    v_or_b32 v16, v16, v19
    v_cmp_ne_u32 vcc, 0, v16
    s_sub_u32 s65, s65, 1
    s_cbranch_scc1 FWD_83
    s_cmp_eq_u64 vcc, 0
    s_cbranch_scc1 FWD_83
    s_sleep 8
    s_branch FW_82
FWD_83:
    v_mov_b32 v7, 1
    ds_write_b32 v6, v7
    s_branch RLD_81
RL_80:
    s_mov_b32 s65, 1048576
LW_84:
    ds_read_b32 v7, v6
    s_waitcnt lgkmcnt(0)
    v_readfirstlane_b32 s64, v7
    s_sub_u32 s65, s65, 1
    s_cbranch_scc1 LWD_85
    s_cmp_lt_u32 s64, 1
    s_cbranch_scc0 LWD_85
    s_sleep 1
    s_branch LW_84
LWD_85:
RLD_81:
    s_lshl_b32 s56, s2, 4
    s_add_u32 s56, s56, s3
    s_cmp_lg_u32 s56, 8
    s_cbranch_scc1 L_TAG_KEEP
    v_mov_b32 v6, 0
    s_mov_b64 exec, 1
    global_store_dword v6, v6, s[30:31] sc1
    s_mov_b64 exec, -1
L_TAG_KEEP:
    s_lshl_b32 s53, s53, 2
    s_add_u32 s53, s53, s51
    v_lshlrev_b32 v6, 12, v4
    v_lshl_add_u32 v6, v3, 9, v6
    s_lshl_b32 s54, s53, 17
    s_lshr_b32 s55, s52, 5
    s_lshl_b32 s55, s55, 11
    s_add_u32 s54, s54, s55
    s_and_b32 s55, s52, 31
    s_lshl_b32 s55, s55, 4
    s_add_u32 s54, s54, s55
    s_add_u32 s54, s54, 10878976
    s_lshl_b32 s55, s52, 7
    s_add_u32 s55, s55, 13565952
    v_lshlrev_b32 v7, 2, v2
    buffer_load_dwordx4 v[32:35], v6, s[40:43], s54 offen sc1
    buffer_load_dwordx4 v[36:39], v6, s[40:43], s54 offen offset:1024 sc1
    buffer_load_dword v5, v7, s[40:43], s55 offen sc1
    s_lshl_b32 s54, s53, 15
    s_add_u32 s54, s54, 13041664
    buffer_load_dwordx4 v[40:43], v1, s[40:43], s54 offen offset:0 sc1
    buffer_load_dwordx4 v[44:47], v1, s[40:43], s54 offen offset:1024 sc1
    buffer_load_dwordx4 v[48:51], v1, s[40:43], s54 offen offset:2048 sc1
    buffer_load_dwordx4 v[52:55], v1, s[40:43], s54 offen offset:3072 sc1
    s_add_u32 s54, s54, 4096
    buffer_load_dwordx4 v[56:59], v1, s[40:43], s54 offen offset:0 sc1
    buffer_load_dwordx4 v[60:63], v1, s[40:43], s54 offen offset:1024 sc1
    buffer_load_dwordx4 v[64:67], v1, s[40:43], s54 offen offset:2048 sc1
    buffer_load_dwordx4 v[68:71], v1, s[40:43], s54 offen offset:3072 sc1
    s_add_u32 s54, s54, 4096
    buffer_load_dwordx4 v[72:75], v1, s[40:43], s54 offen offset:0 sc1
    buffer_load_dwordx4 v[76:79], v1, s[40:43], s54 offen offset:1024 sc1
    buffer_load_dwordx4 v[80:83], v1, s[40:43], s54 offen offset:2048 sc1
    buffer_load_dwordx4 v[84:87], v1, s[40:43], s54 offen offset:3072 sc1
    s_add_u32 s54, s54, 4096
    buffer_load_dwordx4 v[88:91], v1, s[40:43], s54 offen offset:0 sc1
    buffer_load_dwordx4 v[92:95], v1, s[40:43], s54 offen offset:1024 sc1
    buffer_load_dwordx4 v[96:99], v1, s[40:43], s54 offen offset:2048 sc1
    buffer_load_dwordx4 v[100:103], v1, s[40:43], s54 offen offset:3072 sc1
    s_add_u32 s54, s54, 4096
    buffer_load_dwordx4 v[104:107], v1, s[40:43], s54 offen offset:0 sc1
    buffer_load_dwordx4 v[108:111], v1, s[40:43], s54 offen offset:1024 sc1
    buffer_load_dwordx4 v[112:115], v1, s[40:43], s54 offen offset:2048 sc1
    buffer_load_dwordx4 v[116:119], v1, s[40:43], s54 offen offset:3072 sc1
    s_add_u32 s54, s54, 4096
    buffer_load_dwordx4 v[120:123], v1, s[40:43], s54 offen offset:0 sc1
    buffer_load_dwordx4 v[124:127], v1, s[40:43], s54 offen offset:1024 sc1
    buffer_load_dwordx4 v[128:131], v1, s[40:43], s54 offen offset:2048 sc1
    buffer_load_dwordx4 v[132:135], v1, s[40:43], s54 offen offset:3072 sc1
    s_add_u32 s54, s54, 4096
    buffer_load_dwordx4 v[136:139], v1, s[40:43], s54 offen offset:0 sc1
    buffer_load_dwordx4 v[140:143], v1, s[40:43], s54 offen offset:1024 sc1
    buffer_load_dwordx4 v[144:147], v1, s[40:43], s54 offen offset:2048 sc1
    buffer_load_dwordx4 v[148:151], v1, s[40:43], s54 offen offset:3072 sc1
    s_add_u32 s54, s54, 4096
    buffer_load_dwordx4 v[152:155], v1, s[40:43], s54 offen offset:0 sc1
    buffer_load_dwordx4 v[156:159], v1, s[40:43], s54 offen offset:1024 sc1
    buffer_load_dwordx4 v[160:163], v1, s[40:43], s54 offen offset:2048 sc1
    buffer_load_dwordx4 v[164:167], v1, s[40:43], s54 offen offset:3072 sc1
    s_waitcnt vmcnt(32)
    v_mfma_f32_32x32x16_bf16 v[16:31], v[32:35], v[8:11], 0
    v_mfma_f32_32x32x16_bf16 v[16:31], v[36:39], v[12:15], v[16:31]
    v_sub_f32 v7, 1.0, v5
    v_lshlrev_b32 v6, 10, v2
    v_lshl_add_u32 v6, v3, 4, v6
    s_nop 8
    v_pk_mul_f32 v[16:17], v[16:17], v[6:7] op_sel:[0,1] op_sel_hi:[1,1]
    v_pk_mul_f32 v[18:19], v[18:19], v[6:7] op_sel:[0,1] op_sel_hi:[1,1]
    v_pk_mul_f32 v[20:21], v[20:21], v[6:7] op_sel:[0,1] op_sel_hi:[1,1]
    v_pk_mul_f32 v[22:23], v[22:23], v[6:7] op_sel:[0,1] op_sel_hi:[1,1]
    v_pk_mul_f32 v[24:25], v[24:25], v[6:7] op_sel:[0,1] op_sel_hi:[1,1]
    v_pk_mul_f32 v[26:27], v[26:27], v[6:7] op_sel:[0,1] op_sel_hi:[1,1]
    v_pk_mul_f32 v[28:29], v[28:29], v[6:7] op_sel:[0,1] op_sel_hi:[1,1]
    v_pk_mul_f32 v[30:31], v[30:31], v[6:7] op_sel:[0,1] op_sel_hi:[1,1]
    v_cvt_pk_bf16_f32 v8, v16, v17
    v_cvt_pk_bf16_f32 v9, v18, v19
    v_cvt_pk_bf16_f32 v10, v20, v21
    v_cvt_pk_bf16_f32 v11, v22, v23
    v_cvt_pk_bf16_f32 v12, v24, v25
    v_cvt_pk_bf16_f32 v13, v26, v27
    v_cvt_pk_bf16_f32 v14, v28, v29
    v_cvt_pk_bf16_f32 v15, v30, v31
    s_mul_i32 s54, s52, 4352
    s_add_u32 s54, s54, 13840640
    s_lshl_b32 s55, s52, 15
    s_add_u32 s55, s55, 6553600
    s_lshl_b32 s56, s51, 10
    s_add_u32 s55, s55, s56
    s_lshl_b32 s57, s52, 15
    s_lshl_b32 s58, s53, 6
    s_add_u32 s57, s57, s58
    v_lshlrev_b32 v7, 7, v2
    s_mul_i32 s58, s51, 2560
    s_add_u32 s58, s58, 97792
    v_mul_u32_u24 v2, 80, v2
    v_lshl_add_u32 v2, v3, 4, v2
    v_add_u32 v2, s58, v2
    v_lshrrev_b32 v6, 2, v0
    v_and_b32 v0, 3, v0
    v_mul_u32_u24 v3, 80, v6
    v_lshl_add_u32 v3, v0, 4, v3
    v_add_u32 v3, s58, v3
    v_lshlrev_b32 v6, 10, v6
    v_lshl_add_u32 v6, v0, 4, v6
    s_mov_b32 s44, s28
    s_and_b32 s45, s29, 0xffff
    s_mov_b32 s46, 0x200000
    s_mov_b32 s47, 0x20000
    s_barrier
    s_barrier
    s_cmp_lg_u32 s3, 8
    s_cbranch_scc1 L_OWAIT
    s_mov_b32 s65, 131072
FW_86:
    buffer_load_dword v32, v7, s[40:43], s54 offen sc1
    s_waitcnt vmcnt(0)
    v_xor_b32 v32, s50, v32
    v_cmp_ne_u32 vcc, 0, v32
    s_sub_u32 s65, s65, 1
    s_cbranch_scc1 FWD_87
    s_cmp_eq_u64 vcc, 0
    s_cbranch_scc1 FWD_87
    s_sleep 1
    s_branch FW_86
FWD_87:
L_OWAIT:
    s_waitcnt vmcnt(0)
    s_barrier
    s_add_u32 m0, s56, 32256
    s_nop 0
    buffer_load_dwordx4 v1, s[40:43], s55 offen sc1 lds
    s_add_u32 s55, s55, 4096
    s_add_u32 m0, s56, 36352
    s_nop 0
    buffer_load_dwordx4 v1, s[40:43], s55 offen sc1 lds
    s_add_u32 s55, s55, 4096
    s_add_u32 m0, s56, 40448
    s_nop 0
    buffer_load_dwordx4 v1, s[40:43], s55 offen sc1 lds
    s_add_u32 s55, s55, 4096
    s_add_u32 m0, s56, 44544
    s_nop 0
    buffer_load_dwordx4 v1, s[40:43], s55 offen sc1 lds
    s_add_u32 s55, s55, 4096
    s_add_u32 m0, s56, 48640
    s_nop 0
    buffer_load_dwordx4 v1, s[40:43], s55 offen sc1 lds
    s_add_u32 s55, s55, 4096
    s_add_u32 m0, s56, 52736
    s_nop 0
    buffer_load_dwordx4 v1, s[40:43], s55 offen sc1 lds
    s_add_u32 s55, s55, 4096
    s_add_u32 m0, s56, 56832
    s_nop 0
    buffer_load_dwordx4 v1, s[40:43], s55 offen sc1 lds
    s_add_u32 s55, s55, 4096
    s_add_u32 m0, s56, 60928
    s_nop 0
    buffer_load_dwordx4 v1, s[40:43], s55 offen sc1 lds
    s_add_u32 s55, s55, 4096
    s_waitcnt vmcnt(6)
    s_barrier
    ds_read_b128 v[32:35], v1 offset:32256
    ds_read_b128 v[36:39], v1 offset:33280
    s_waitcnt lgkmcnt(1)
    v_mfma_f32_32x32x16_bf16 v[16:31], v[40:43], v[32:35], 0
    ds_read_b128 v[32:35], v1 offset:34304
    s_waitcnt lgkmcnt(1)
    v_mfma_f32_32x32x16_bf16 v[16:31], v[44:47], v[36:39], v[16:31]
    ds_read_b128 v[36:39], v1 offset:35328
    s_waitcnt lgkmcnt(1)
    v_mfma_f32_32x32x16_bf16 v[16:31], v[48:51], v[32:35], v[16:31]
    ds_read_b128 v[32:35], v1 offset:36352
    s_waitcnt lgkmcnt(1)
    v_mfma_f32_32x32x16_bf16 v[16:31], v[52:55], v[36:39], v[16:31]
    ds_read_b128 v[36:39], v1 offset:37376
    s_waitcnt lgkmcnt(1)
    v_mfma_f32_32x32x16_bf16 v[16:31], v[56:59], v[32:35], v[16:31]
    ds_read_b128 v[32:35], v1 offset:38400
    s_waitcnt lgkmcnt(1)
    v_mfma_f32_32x32x16_bf16 v[16:31], v[60:63], v[36:39], v[16:31]
    ds_read_b128 v[36:39], v1 offset:39424
    s_waitcnt lgkmcnt(1)
    v_mfma_f32_32x32x16_bf16 v[16:31], v[64:67], v[32:35], v[16:31]
    s_waitcnt lgkmcnt(0)
    v_mfma_f32_32x32x16_bf16 v[16:31], v[68:71], v[36:39], v[16:31]
    s_waitcnt vmcnt(4)
    s_barrier
    ds_read_b128 v[32:35], v1 offset:40448
    ds_read_b128 v[36:39], v1 offset:41472
    s_waitcnt lgkmcnt(1)
    v_mfma_f32_32x32x16_bf16 v[16:31], v[72:75], v[32:35], v[16:31]
    ds_read_b128 v[32:35], v1 offset:42496
    s_waitcnt lgkmcnt(1)
    v_mfma_f32_32x32x16_bf16 v[16:31], v[76:79], v[36:39], v[16:31]
    ds_read_b128 v[36:39], v1 offset:43520
    s_waitcnt lgkmcnt(1)
    v_mfma_f32_32x32x16_bf16 v[16:31], v[80:83], v[32:35], v[16:31]
    ds_read_b128 v[32:35], v1 offset:44544
    s_waitcnt lgkmcnt(1)
    v_mfma_f32_32x32x16_bf16 v[16:31], v[84:87], v[36:39], v[16:31]
    ds_read_b128 v[36:39], v1 offset:45568
    s_waitcnt lgkmcnt(1)
    v_mfma_f32_32x32x16_bf16 v[16:31], v[88:91], v[32:35], v[16:31]
    ds_read_b128 v[32:35], v1 offset:46592
    s_waitcnt lgkmcnt(1)
    v_mfma_f32_32x32x16_bf16 v[16:31], v[92:95], v[36:39], v[16:31]
    ds_read_b128 v[36:39], v1 offset:47616
    s_waitcnt lgkmcnt(1)
    v_mfma_f32_32x32x16_bf16 v[16:31], v[96:99], v[32:35], v[16:31]
    s_waitcnt lgkmcnt(0)
    v_mfma_f32_32x32x16_bf16 v[16:31], v[100:103], v[36:39], v[16:31]
    s_waitcnt vmcnt(2)
    s_barrier
    ds_read_b128 v[32:35], v1 offset:48640
    ds_read_b128 v[36:39], v1 offset:49664
    s_waitcnt lgkmcnt(1)
    v_mfma_f32_32x32x16_bf16 v[16:31], v[104:107], v[32:35], v[16:31]
    ds_read_b128 v[32:35], v1 offset:50688
    s_waitcnt lgkmcnt(1)
    v_mfma_f32_32x32x16_bf16 v[16:31], v[108:111], v[36:39], v[16:31]
    ds_read_b128 v[36:39], v1 offset:51712
    s_waitcnt lgkmcnt(1)
    v_mfma_f32_32x32x16_bf16 v[16:31], v[112:115], v[32:35], v[16:31]
    ds_read_b128 v[32:35], v1 offset:52736
    s_waitcnt lgkmcnt(1)
    v_mfma_f32_32x32x16_bf16 v[16:31], v[116:119], v[36:39], v[16:31]
    ds_read_b128 v[36:39], v1 offset:53760
    s_waitcnt lgkmcnt(1)
    v_mfma_f32_32x32x16_bf16 v[16:31], v[120:123], v[32:35], v[16:31]
    ds_read_b128 v[32:35], v1 offset:54784
    s_waitcnt lgkmcnt(1)
    v_mfma_f32_32x32x16_bf16 v[16:31], v[124:127], v[36:39], v[16:31]
    ds_read_b128 v[36:39], v1 offset:55808
    s_waitcnt lgkmcnt(1)
    v_mfma_f32_32x32x16_bf16 v[16:31], v[128:131], v[32:35], v[16:31]
    s_waitcnt lgkmcnt(0)
    v_mfma_f32_32x32x16_bf16 v[16:31], v[132:135], v[36:39], v[16:31]
    s_waitcnt vmcnt(0)
    s_barrier
    ds_read_b128 v[32:35], v1 offset:56832
    ds_read_b128 v[36:39], v1 offset:57856
    s_waitcnt lgkmcnt(1)
    v_mfma_f32_32x32x16_bf16 v[16:31], v[136:139], v[32:35], v[16:31]
    ds_read_b128 v[32:35], v1 offset:58880
    s_waitcnt lgkmcnt(1)
    v_mfma_f32_32x32x16_bf16 v[16:31], v[140:143], v[36:39], v[16:31]
    ds_read_b128 v[36:39], v1 offset:59904
    s_waitcnt lgkmcnt(1)
    v_mfma_f32_32x32x16_bf16 v[16:31], v[144:147], v[32:35], v[16:31]
    ds_read_b128 v[32:35], v1 offset:60928
    s_waitcnt lgkmcnt(1)
    v_mfma_f32_32x32x16_bf16 v[16:31], v[148:151], v[36:39], v[16:31]
    ds_read_b128 v[36:39], v1 offset:61952
    s_waitcnt lgkmcnt(1)
    v_mfma_f32_32x32x16_bf16 v[16:31], v[152:155], v[32:35], v[16:31]
    ds_read_b128 v[32:35], v1 offset:62976
    s_waitcnt lgkmcnt(1)
    v_mfma_f32_32x32x16_bf16 v[16:31], v[156:159], v[36:39], v[16:31]
    ds_read_b128 v[36:39], v1 offset:64000
    s_waitcnt lgkmcnt(1)
    v_mfma_f32_32x32x16_bf16 v[16:31], v[160:163], v[32:35], v[16:31]
    s_waitcnt lgkmcnt(0)
    v_mfma_f32_32x32x16_bf16 v[16:31], v[164:167], v[36:39], v[16:31]
    v_lshlrev_b32 v40, 16, v8
    v_and_b32 v41, 0xffff0000, v8
    v_lshlrev_b32 v42, 16, v9
    v_and_b32 v43, 0xffff0000, v9
    v_lshlrev_b32 v44, 16, v10
    v_and_b32 v45, 0xffff0000, v10
    v_lshlrev_b32 v46, 16, v11
    v_and_b32 v47, 0xffff0000, v11
    v_lshlrev_b32 v48, 16, v12
    v_and_b32 v49, 0xffff0000, v12
    v_lshlrev_b32 v50, 16, v13
    v_and_b32 v51, 0xffff0000, v13
    v_lshlrev_b32 v52, 16, v14
    v_and_b32 v53, 0xffff0000, v14
    v_lshlrev_b32 v54, 16, v15
    v_and_b32 v55, 0xffff0000, v15
    v_pk_fma_f32 v[16:17], v[16:17], v[4:5], v[40:41] op_sel:[0,1,0] op_sel_hi:[1,1,1]
    v_pk_fma_f32 v[18:19], v[18:19], v[4:5], v[42:43] op_sel:[0,1,0] op_sel_hi:[1,1,1]
    v_pk_fma_f32 v[20:21], v[20:21], v[4:5], v[44:45] op_sel:[0,1,0] op_sel_hi:[1,1,1]
    v_pk_fma_f32 v[22:23], v[22:23], v[4:5], v[46:47] op_sel:[0,1,0] op_sel_hi:[1,1,1]
    v_pk_fma_f32 v[24:25], v[24:25], v[4:5], v[48:49] op_sel:[0,1,0] op_sel_hi:[1,1,1]
    v_pk_fma_f32 v[26:27], v[26:27], v[4:5], v[50:51] op_sel:[0,1,0] op_sel_hi:[1,1,1]
    v_pk_fma_f32 v[28:29], v[28:29], v[4:5], v[52:53] op_sel:[0,1,0] op_sel_hi:[1,1,1]
    v_pk_fma_f32 v[30:31], v[30:31], v[4:5], v[54:55] op_sel:[0,1,0] op_sel_hi:[1,1,1]
    v_cvt_pk_bf16_f32 v8, v16, v17
    v_cvt_pk_bf16_f32 v9, v18, v19
    v_cvt_pk_bf16_f32 v10, v20, v21
    v_cvt_pk_bf16_f32 v11, v22, v23
    v_cvt_pk_bf16_f32 v12, v24, v25
    v_cvt_pk_bf16_f32 v13, v26, v27
    v_cvt_pk_bf16_f32 v14, v28, v29
    v_cvt_pk_bf16_f32 v15, v30, v31
    ds_write_b128 v2, v[8:11]
    ds_write_b128 v2, v[12:15] offset:32
    s_add_u32 s58, s57, 16384
    s_waitcnt lgkmcnt(0)
    ds_read_b128 v[8:11], v3
    ds_read_b128 v[12:15], v3 offset:1280
    s_waitcnt lgkmcnt(1)
    buffer_store_dwordx4 v[8:11], v6, s[44:47], s57 offen
    s_waitcnt lgkmcnt(0)
    buffer_store_dwordx4 v[12:15], v6, s[44:47], s58 offen
L_END:
    s_endpgm
.section .rodata,"a"
.p2align 6
.amdhsa_kernel gated_mix__softmax_full_mha__ssm_conv_s4d__prompt_kernel
  .amdhsa_next_free_vgpr 168
  .amdhsa_next_free_sgpr 100
  .amdhsa_accum_offset 168
  .amdhsa_group_segment_fixed_size 0
  .amdhsa_kernarg_size 112
  .amdhsa_user_sgpr_count 2
  .amdhsa_user_sgpr_kernarg_segment_ptr 1
  .amdhsa_system_sgpr_workgroup_id_x 1
.end_amdhsa_kernel
```
